```python
import torch

def _softmax(x, axis=-1):
    return torch.softmax(x, dim=axis)
def _gelu(x):
    return torch.nn.functional.gelu(x, approximate="tanh")
def _silu(x):
    return torch.nn.functional.silu(x)
def _sigmoid(x):
    return torch.sigmoid(x)
def _layernorm(x, axis=-1, eps=1e-5):
    m = x.mean(dim=axis, keepdim=True)
    v = x.var(dim=axis, keepdim=True, unbiased=False)
    return (x - m) / torch.sqrt(v + eps)
def _scatter_add(tgt, idx, src, axis=0):
    return tgt.clone().index_add_(axis, idx, src)
def _segment_sum(src, seg, n):
    out = torch.zeros((n,) + src.shape[1:], dtype=src.dtype)
    return out.index_add_(0, seg, src)
def _pad(x, pw):
    flat = tuple(v for pair in reversed(pw) for v in pair)
    return torch.nn.functional.pad(x, flat)

kernel_name = 'sequential_preLN__softmax_full_mha__glu_gated_reglu__prompt'

def setup_inputs():

    _w = (lambda a: (lambda t: t.to(torch.bfloat16) if t.is_floating_point() else t)(torch.as_tensor(a)))
    def _A_setup():
        B, S, D = 1, 2048, 512
        return {
            "x": _w((lambda *s: torch.randn(*s, dtype=torch.bfloat16) * 0.05)(B, S, D)),
            "wqkv": _w((lambda *s: torch.randn(*s, dtype=torch.bfloat16) * 0.05)(D, 3 * D)),
            "wo": _w((lambda *s: torch.randn(*s, dtype=torch.bfloat16) * 0.05)(D, D)),
        }
    _A_in = _A_setup()

    def _B_setup():
        B, S, D, F = 1, 2048, 512, 1792
        return {
            "x": _w((lambda *s: torch.randn(*s, dtype=torch.bfloat16) * 0.05)(B, S, D)),
            "W_gate": _w((lambda *s: torch.randn(*s, dtype=torch.bfloat16) * 0.4)(D, F) * (2.0 / D) ** 0.5),
            "W_up": _w((lambda *s: torch.randn(*s, dtype=torch.bfloat16) * 0.4)(D, F) * (2.0 / D) ** 0.5),
            "W_down": _w((lambda *s: torch.randn(*s, dtype=torch.bfloat16) * 0.4)(F, D) * (1.0 / F) ** 0.5),
        }
    _B_in = _B_setup()

    return {
        "A_x": _A_in["x"],
        "A_wqkv": _A_in["wqkv"],
        "A_wo": _A_in["wo"],
        "B_x": _B_in["x"],
        "B_W_gate": _B_in["W_gate"],
        "B_W_up": _B_in["W_up"],
        "B_W_down": _B_in["W_down"],
    }

def reference(A_x, A_wqkv, A_wo, B_x, B_W_gate, B_W_up, B_W_down):
    def _A_ref(x, wqkv, wo):
        B, S, D = x.shape
        H = 32; Dh = D // H
        qkv = (lambda x, *d: x.permute(*d))((x @ wqkv).reshape(B, S, 3, H, Dh), 2, 0, 3, 1, 4)
        q, k, v = qkv[0], qkv[1], qkv[2]
        scale = Dh ** -0.5
        scores = torch.einsum("bhqd,bhkd->bhqk", q, k) * scale
        p = _softmax(scores, axis=-1)
        o = torch.einsum("bhqk,bhkd->bhqd", p, v)
        return (lambda x, *d: x.permute(*d))(o, 0, 2, 1, 3).reshape(B, S, D) @ wo

    def _B_ref(x, W_gate, W_up, W_down):
        gate = torch.einsum("bsd,df->bsf", x, W_gate)
        up = torch.einsum("bsd,df->bsf", x, W_up)
        gate = gate * (lambda x, dt: x.to(dt))(gate > 0, gate.dtype)
        h = gate * up
        return torch.einsum("bsf,fd->bsd", h, W_down)

    x = A_x
    h = x + _A_ref(_layernorm(x, axis=-1), A_wqkv, A_wo)
    h2 = h + _B_ref(_layernorm(h, axis=-1), B_W_gate, B_W_up, B_W_down)
    return h2
```

```asm
; @launch kernel=k1_lnqkv_kernel grid=(256,1,1) block=(512,1,1) lds=163840
; @launch kernel=k2_attn_kernel grid=(256,1,1) block=(1024,1,1) lds=163840
; @launch kernel=k3_oproj_kernel grid=(312,1,1) block=(256,1,1) lds=65536
; @launch kernel=k4_ffn1_kernel grid=(256,1,1) block=(256,1,1) lds=145664
; @launch kernel=k5_down_kernel grid=(256,1,1) block=(256,1,1) lds=114688
.amdgcn_target "amdgcn-amd-amdhsa--gfx950"
.text
.globl k1_lnqkv_kernel
.p2align 8
.type k1_lnqkv_kernel,@function
k1_lnqkv_kernel:

    s_cmp_ge_u32 s2, 256
    s_cbranch_scc1 L_k1_end
    s_load_dwordx2 s[4:5], s[0:1], 0
    s_load_dwordx2 s[6:7], s[0:1], 8
    s_load_dwordx2 s[8:9], s[0:1], 72
    v_and_b32 v1, 63, v0
    s_getpc_b64 s[44:45]
L_pc_1:
    s_sub_u32 s44, s44, L_pc_1-k1_lnqkv_kernel
    s_subb_u32 s45, s45, 0
    v_lshlrev_b32 v2, 7, v1
    v_min_u32 v2, k1_lnqkv_kernel_codeend-k1_lnqkv_kernel-4, v2
    global_load_dword v10, v2, s[44:45]
    v_lshrrev_b32 v2, 6, v0
    s_nop 0
    v_readfirstlane_b32 s26, v2
    s_and_b32 s27, s2, 7
    s_lshr_b32 s28, s2, 3
    s_and_b32 s24, s27, 3
    s_lshl_b32 s24, s24, 2
    s_and_b32 s25, s28, 3
    s_add_u32 s24, s24, s25
    s_lshr_b32 s25, s27, 2
    s_lshl_b32 s25, s25, 3
    s_lshr_b32 s28, s28, 2
    s_add_u32 s25, s25, s28
    v_and_b32 v5, 31, v1
    v_lshrrev_b32 v4, 5, v1
    s_and_b32 s33, s26, 3
    s_lshr_b32 s34, s26, 2
    s_lshl_b32 s32, s24, 7
    s_lshl_b32 s27, s33, 5
    s_add_u32 s32, s32, s27
    v_add_u32 v5, s32, v5
    v_lshlrev_b32 v6, 10, v5
    v_lshl_add_u32 v6, v4, 4, v6
    s_waitcnt lgkmcnt(0)
    s_mov_b32 s16, s6
    s_mov_b32 s17, s7
    s_and_b32 s17, s17, 0xffff
    s_mov_b32 s18, 1572864
    s_mov_b32 s19, 0x00020000
    v_add_u32 v2, 0, v1
    v_mul_u32_u24 v3, 171, v2
    v_lshrrev_b32 v3, 11, v3
    v_mul_u32_u24 v7, 12, v3
    v_sub_u32 v2, v2, v7
    v_mul_u32_u24 v7, 3072, v3
    v_lshl_add_u32 v7, v2, 4, v7
    v_add_u32 v2, 64, v1
    v_mul_u32_u24 v3, 171, v2
    v_lshrrev_b32 v3, 11, v3
    v_mul_u32_u24 v8, 12, v3
    v_sub_u32 v2, v2, v8
    v_mul_u32_u24 v8, 3072, v3
    v_lshl_add_u32 v8, v2, 4, v8
    v_add_u32 v2, 128, v1
    v_mul_u32_u24 v3, 171, v2
    v_lshrrev_b32 v3, 11, v3
    v_mul_u32_u24 v9, 12, v3
    v_sub_u32 v2, v2, v9
    v_mul_u32_u24 v9, 3072, v3
    v_lshl_add_u32 v9, v2, 4, v9
    s_lshl_b32 s27, s34, 4
    s_add_u32 s27, s27, s33
    s_mul_i32 s29, s27, 49152
    s_mul_i32 s28, s25, 192
    s_add_u32 s29, s29, s28
    s_mul_i32 s30, s27, 3072
    s_add_u32 s31, s29, 0
    s_add_u32 m0, s30, 0
    s_nop 0
    buffer_load_dwordx4 v7, s[16:19], s31 offen lds
    s_add_u32 m0, s30, 1024
    s_nop 0
    buffer_load_dwordx4 v8, s[16:19], s31 offen lds
    s_add_u32 m0, s30, 2048
    s_nop 0
    buffer_load_dwordx4 v9, s[16:19], s31 offen lds
    s_mov_b32 s12, s4
    s_mov_b32 s13, s5
    s_and_b32 s13, s13, 0xffff
    s_mov_b32 s14, 2097152
    s_mov_b32 s15, 0x00020000
    v_lshrrev_b32 v2, 3, v1
    v_lshlrev_b32 v76, 10, v2
    v_and_b32 v2, 7, v1
    v_lshrrev_b32 v3, 4, v1
    v_xor_b32 v2, v2, v3
    v_lshl_add_u32 v76, v2, 4, v76
    v_xor_b32 v77, 64, v76
    s_lshl_b32 s44, s32, 10
    s_lshl_b32 s27, s34, 9
    s_add_u32 s44, s44, s27
    s_lshl_b32 s45, s26, 13
    s_add_u32 s45, s45, 98304
    s_add_u32 m0, s45, 0
    s_add_u32 s27, s44, 0
    buffer_load_dwordx4 v76, s[12:15], s27 offen lds
    s_add_u32 m0, s45, 1024
    s_add_u32 s27, s44, 8192
    buffer_load_dwordx4 v77, s[12:15], s27 offen lds
    s_add_u32 m0, s45, 2048
    s_add_u32 s27, s44, 16384
    buffer_load_dwordx4 v76, s[12:15], s27 offen lds
    s_add_u32 m0, s45, 3072
    s_add_u32 s27, s44, 24576
    buffer_load_dwordx4 v77, s[12:15], s27 offen lds
    s_add_u32 m0, s45, 4096
    s_add_u32 s27, s44, 128
    buffer_load_dwordx4 v76, s[12:15], s27 offen lds
    s_add_u32 m0, s45, 5120
    s_add_u32 s27, s44, 8320
    buffer_load_dwordx4 v77, s[12:15], s27 offen lds
    s_add_u32 m0, s45, 6144
    s_add_u32 s27, s44, 16512
    buffer_load_dwordx4 v76, s[12:15], s27 offen lds
    s_add_u32 m0, s45, 7168
    s_add_u32 s27, s44, 24704
    buffer_load_dwordx4 v77, s[12:15], s27 offen lds
    v_and_b32 v2, 31, v1
    v_lshlrev_b32 v78, 7, v2
    v_bfe_u32 v2, v1, 1, 3
    v_lshrrev_b32 v3, 5, v1
    v_xor_b32 v2, v2, v3
    v_lshl_add_u32 v78, v2, 4, v78
    v_add_u32 v78, s45, v78
    v_xor_b32 v79, 32, v78
    v_xor_b32 v80, 64, v78
    v_xor_b32 v81, 96, v78
    s_getpc_b64 s[48:49]
L_pc_2:
    s_add_u32 s48, s48, k2_attn_kernel-L_pc_2
    s_addc_u32 s49, s49, 0
    v_lshlrev_b32 v2, 7, v1
    v_min_u32 v2, k2_attn_kernel_codeend-k2_attn_kernel-4, v2
    global_load_dword v82, v2, s[48:49]
    v_lshrrev_b32 v2, 5, v1
    v_lshlrev_b32 v2, 3, v2
    v_bfe_u32 v3, v1, 2, 2
    v_add_u32 v2, v2, v3
    v_mul_u32_u24 v83, 192, v2
    v_bfe_u32 v2, v1, 4, 1
    v_lshlrev_b32 v2, 5, v2
    v_add_u32 v83, v83, v2
    v_and_b32 v2, 3, v1
    v_lshl_add_u32 v83, v2, 3, v83
    s_mul_i32 s27, s34, 49152
    v_add_u32 v83, s27, v83
    v_mov_b32 v84, 0x3f803f80
    v_mov_b32 v85, 0
    v_mov_b32 v86, 0
    v_mov_b32 v87, 0
    v_mov_b32 v88, 0
    s_waitcnt vmcnt(5)
    ds_read_b128 v[12:15], v78 offset:0
    ds_read_b128 v[16:19], v79 offset:0
    ds_read_b128 v[20:23], v80 offset:0
    ds_read_b128 v[24:27], v81 offset:0
    s_waitcnt lgkmcnt(0)
    s_add_u32 m0, s45, 0
    s_add_u32 s27, s44, 256
    buffer_load_dwordx4 v76, s[12:15], s27 offen lds
    s_add_u32 m0, s45, 1024
    s_add_u32 s27, s44, 8448
    buffer_load_dwordx4 v77, s[12:15], s27 offen lds
    s_add_u32 m0, s45, 2048
    s_add_u32 s27, s44, 16640
    buffer_load_dwordx4 v76, s[12:15], s27 offen lds
    s_add_u32 m0, s45, 3072
    s_add_u32 s27, s44, 24832
    buffer_load_dwordx4 v77, s[12:15], s27 offen lds
    v_dot2_f32_bf16 v85, v12, v84, v85
    v_dot2_f32_bf16 v86, v13, v84, v86
    v_dot2_f32_bf16 v87, v14, v84, v87
    v_dot2_f32_bf16 v88, v15, v84, v88
    v_dot2_f32_bf16 v85, v16, v84, v85
    v_dot2_f32_bf16 v86, v17, v84, v86
    v_dot2_f32_bf16 v87, v18, v84, v87
    v_dot2_f32_bf16 v88, v19, v84, v88
    v_dot2_f32_bf16 v85, v20, v84, v85
    v_dot2_f32_bf16 v86, v21, v84, v86
    v_dot2_f32_bf16 v87, v22, v84, v87
    v_dot2_f32_bf16 v88, v23, v84, v88
    v_dot2_f32_bf16 v85, v24, v84, v85
    v_dot2_f32_bf16 v86, v25, v84, v86
    v_dot2_f32_bf16 v87, v26, v84, v87
    v_dot2_f32_bf16 v88, v27, v84, v88
    s_waitcnt vmcnt(5)
    ds_read_b128 v[28:31], v78 offset:4096
    ds_read_b128 v[32:35], v79 offset:4096
    ds_read_b128 v[36:39], v80 offset:4096
    ds_read_b128 v[40:43], v81 offset:4096
    s_waitcnt lgkmcnt(0)
    s_add_u32 m0, s45, 4096
    s_add_u32 s27, s44, 384
    buffer_load_dwordx4 v76, s[12:15], s27 offen lds
    s_add_u32 m0, s45, 5120
    s_add_u32 s27, s44, 8576
    buffer_load_dwordx4 v77, s[12:15], s27 offen lds
    s_add_u32 m0, s45, 6144
    s_add_u32 s27, s44, 16768
    buffer_load_dwordx4 v76, s[12:15], s27 offen lds
    s_add_u32 m0, s45, 7168
    s_add_u32 s27, s44, 24960
    buffer_load_dwordx4 v77, s[12:15], s27 offen lds
    v_dot2_f32_bf16 v85, v28, v84, v85
    v_dot2_f32_bf16 v86, v29, v84, v86
    v_dot2_f32_bf16 v87, v30, v84, v87
    v_dot2_f32_bf16 v88, v31, v84, v88
    v_dot2_f32_bf16 v85, v32, v84, v85
    v_dot2_f32_bf16 v86, v33, v84, v86
    v_dot2_f32_bf16 v87, v34, v84, v87
    v_dot2_f32_bf16 v88, v35, v84, v88
    v_dot2_f32_bf16 v85, v36, v84, v85
    v_dot2_f32_bf16 v86, v37, v84, v86
    v_dot2_f32_bf16 v87, v38, v84, v87
    v_dot2_f32_bf16 v88, v39, v84, v88
    v_dot2_f32_bf16 v85, v40, v84, v85
    v_dot2_f32_bf16 v86, v41, v84, v86
    v_dot2_f32_bf16 v87, v42, v84, v87
    v_dot2_f32_bf16 v88, v43, v84, v88
    s_waitcnt vmcnt(4)
    ds_read_b128 v[44:47], v78 offset:0
    ds_read_b128 v[48:51], v79 offset:0
    ds_read_b128 v[52:55], v80 offset:0
    ds_read_b128 v[56:59], v81 offset:0
    s_waitcnt lgkmcnt(3)
    v_dot2_f32_bf16 v85, v44, v84, v85
    v_dot2_f32_bf16 v86, v45, v84, v86
    v_dot2_f32_bf16 v87, v46, v84, v87
    v_dot2_f32_bf16 v88, v47, v84, v88
    s_waitcnt lgkmcnt(2)
    v_dot2_f32_bf16 v85, v48, v84, v85
    v_dot2_f32_bf16 v86, v49, v84, v86
    v_dot2_f32_bf16 v87, v50, v84, v87
    v_dot2_f32_bf16 v88, v51, v84, v88
    s_waitcnt lgkmcnt(1)
    v_dot2_f32_bf16 v85, v52, v84, v85
    v_dot2_f32_bf16 v86, v53, v84, v86
    v_dot2_f32_bf16 v87, v54, v84, v87
    v_dot2_f32_bf16 v88, v55, v84, v88
    s_waitcnt lgkmcnt(0)
    v_dot2_f32_bf16 v85, v56, v84, v85
    v_dot2_f32_bf16 v86, v57, v84, v86
    v_dot2_f32_bf16 v87, v58, v84, v87
    v_dot2_f32_bf16 v88, v59, v84, v88
    s_waitcnt vmcnt(0)
    ds_read_b128 v[60:63], v78 offset:4096
    ds_read_b128 v[64:67], v79 offset:4096
    ds_read_b128 v[68:71], v80 offset:4096
    ds_read_b128 v[72:75], v81 offset:4096
    s_waitcnt lgkmcnt(3)
    v_dot2_f32_bf16 v85, v60, v84, v85
    v_dot2_f32_bf16 v86, v61, v84, v86
    v_dot2_f32_bf16 v87, v62, v84, v87
    v_dot2_f32_bf16 v88, v63, v84, v88
    s_waitcnt lgkmcnt(2)
    v_dot2_f32_bf16 v85, v64, v84, v85
    v_dot2_f32_bf16 v86, v65, v84, v86
    v_dot2_f32_bf16 v87, v66, v84, v87
    v_dot2_f32_bf16 v88, v67, v84, v88
    s_waitcnt lgkmcnt(1)
    v_dot2_f32_bf16 v85, v68, v84, v85
    v_dot2_f32_bf16 v86, v69, v84, v86
    v_dot2_f32_bf16 v87, v70, v84, v87
    v_dot2_f32_bf16 v88, v71, v84, v88
    s_waitcnt lgkmcnt(0)
    v_dot2_f32_bf16 v85, v72, v84, v85
    v_dot2_f32_bf16 v86, v73, v84, v86
    v_dot2_f32_bf16 v87, v74, v84, v87
    v_dot2_f32_bf16 v88, v75, v84, v88
    s_add_u32 s31, s29, 196608
    s_add_u32 m0, s30, 12288
    s_nop 0
    buffer_load_dwordx4 v7, s[16:19], s31 offen lds
    s_add_u32 m0, s30, 13312
    s_nop 0
    buffer_load_dwordx4 v8, s[16:19], s31 offen lds
    s_add_u32 m0, s30, 14336
    s_nop 0
    buffer_load_dwordx4 v9, s[16:19], s31 offen lds
    s_add_u32 s31, s29, 393216
    s_add_u32 m0, s30, 24576
    s_nop 0
    buffer_load_dwordx4 v7, s[16:19], s31 offen lds
    s_add_u32 m0, s30, 25600
    s_nop 0
    buffer_load_dwordx4 v8, s[16:19], s31 offen lds
    s_add_u32 m0, s30, 26624
    s_nop 0
    buffer_load_dwordx4 v9, s[16:19], s31 offen lds
    s_add_u32 s31, s29, 589824
    s_add_u32 m0, s30, 36864
    s_nop 0
    buffer_load_dwordx4 v7, s[16:19], s31 offen lds
    s_add_u32 m0, s30, 37888
    s_nop 0
    buffer_load_dwordx4 v8, s[16:19], s31 offen lds
    s_add_u32 m0, s30, 38912
    s_nop 0
    buffer_load_dwordx4 v9, s[16:19], s31 offen lds
    v_add_f32 v85, v85, v86
    v_add_f32 v87, v87, v88
    v_add_f32 v89, v85, v87
    v_mov_b32 v2, v89
    v_mov_b32 v3, v89
    s_nop 1
    v_permlane32_swap_b32 v2, v3
    v_add_f32 v89, v2, v3
    v_and_b32 v2, 31, v1
    v_lshlrev_b32 v92, 2, v2
    v_add_u32 v2, s45, v92
    ds_write_b32 v2, v89
    s_waitcnt lgkmcnt(0)
    s_barrier
    s_xor_b32 s27, s26, 4
    s_lshl_b32 s27, s27, 13
    s_add_u32 s27, s27, 98304
    v_add_u32 v2, s27, v92
    ds_read_b32 v3, v2
    s_waitcnt lgkmcnt(0)
    v_add_f32 v89, v89, v3
    v_mul_f32 v89, 0x3b000000, v89
    v_cvt_pk_bf16_f32 v2, v89, v89
    v_and_b32 v90, 0xffff0000, v2
    v_sub_f32 v91, v90, v89
    v_sub_f32 v90, 0, v90
    v_mov_b32 v176, 0
    v_mov_b32 v177, 0
    ds_read_b64_tr_b16 v[144:145], v83 offset:0
    ds_read_b64_tr_b16 v[146:147], v83 offset:768
    ds_read_b64_tr_b16 v[148:149], v83 offset:64
    ds_read_b64_tr_b16 v[150:151], v83 offset:832
    ds_read_b64_tr_b16 v[152:153], v83 offset:128
    ds_read_b64_tr_b16 v[154:155], v83 offset:896
    v_lshlrev_b32 v168, 16, v12
    v_and_b32 v169, 0xffff0000, v12
    v_add_f32 v168, v168, v90
    v_add_f32 v169, v169, v90
    v_fmac_f32 v176, v168, v168
    v_fmac_f32 v177, v169, v169
    v_cvt_pk_bf16_f32 v12, v168, v169
    v_lshlrev_b32 v170, 16, v13
    v_and_b32 v171, 0xffff0000, v13
    v_add_f32 v170, v170, v90
    v_add_f32 v171, v171, v90
    v_fmac_f32 v176, v170, v170
    v_fmac_f32 v177, v171, v171
    v_cvt_pk_bf16_f32 v13, v170, v171
    v_lshlrev_b32 v172, 16, v14
    v_and_b32 v173, 0xffff0000, v14
    v_add_f32 v172, v172, v90
    v_add_f32 v173, v173, v90
    v_fmac_f32 v176, v172, v172
    v_fmac_f32 v177, v173, v173
    v_cvt_pk_bf16_f32 v14, v172, v173
    v_lshlrev_b32 v174, 16, v15
    v_and_b32 v175, 0xffff0000, v15
    v_add_f32 v174, v174, v90
    v_add_f32 v175, v175, v90
    v_fmac_f32 v176, v174, v174
    v_fmac_f32 v177, v175, v175
    v_cvt_pk_bf16_f32 v15, v174, v175
    ds_read_b64_tr_b16 v[156:157], v83 offset:3072
    ds_read_b64_tr_b16 v[158:159], v83 offset:3840
    ds_read_b64_tr_b16 v[160:161], v83 offset:3136
    ds_read_b64_tr_b16 v[162:163], v83 offset:3904
    ds_read_b64_tr_b16 v[164:165], v83 offset:3200
    ds_read_b64_tr_b16 v[166:167], v83 offset:3968
    s_waitcnt lgkmcnt(10)
    v_mfma_f32_32x32x16_bf16 v[96:111], v[144:147], v[12:15], 0
    v_lshlrev_b32 v168, 16, v16
    v_and_b32 v169, 0xffff0000, v16
    v_add_f32 v168, v168, v90
    v_add_f32 v169, v169, v90
    v_fmac_f32 v176, v168, v168
    v_fmac_f32 v177, v169, v169
    v_cvt_pk_bf16_f32 v16, v168, v169
    v_lshlrev_b32 v170, 16, v17
    v_and_b32 v171, 0xffff0000, v17
    v_add_f32 v170, v170, v90
    s_waitcnt lgkmcnt(8)
    v_mfma_f32_32x32x16_bf16 v[112:127], v[148:151], v[12:15], 0
    v_add_f32 v171, v171, v90
    v_fmac_f32 v176, v170, v170
    v_fmac_f32 v177, v171, v171
    v_cvt_pk_bf16_f32 v17, v170, v171
    v_lshlrev_b32 v172, 16, v18
    v_and_b32 v173, 0xffff0000, v18
    v_add_f32 v172, v172, v90
    v_add_f32 v173, v173, v90
    v_fmac_f32 v176, v172, v172
    s_waitcnt lgkmcnt(6)
    v_mfma_f32_32x32x16_bf16 v[128:143], v[152:155], v[12:15], 0
    v_fmac_f32 v177, v173, v173
    v_cvt_pk_bf16_f32 v18, v172, v173
    v_lshlrev_b32 v174, 16, v19
    v_and_b32 v175, 0xffff0000, v19
    v_add_f32 v174, v174, v90
    v_add_f32 v175, v175, v90
    v_fmac_f32 v176, v174, v174
    v_fmac_f32 v177, v175, v175
    v_cvt_pk_bf16_f32 v19, v174, v175
    ds_read_b64_tr_b16 v[144:145], v83 offset:6144
    ds_read_b64_tr_b16 v[146:147], v83 offset:6912
    ds_read_b64_tr_b16 v[148:149], v83 offset:6208
    ds_read_b64_tr_b16 v[150:151], v83 offset:6976
    ds_read_b64_tr_b16 v[152:153], v83 offset:6272
    ds_read_b64_tr_b16 v[154:155], v83 offset:7040
    s_waitcnt lgkmcnt(10)
    v_mfma_f32_32x32x16_bf16 v[96:111], v[156:159], v[16:19], v[96:111]
    v_lshlrev_b32 v168, 16, v20
    v_and_b32 v169, 0xffff0000, v20
    v_add_f32 v168, v168, v90
    v_add_f32 v169, v169, v90
    v_fmac_f32 v176, v168, v168
    v_fmac_f32 v177, v169, v169
    v_cvt_pk_bf16_f32 v20, v168, v169
    v_lshlrev_b32 v170, 16, v21
    v_and_b32 v171, 0xffff0000, v21
    v_add_f32 v170, v170, v90
    s_waitcnt lgkmcnt(8)
    v_mfma_f32_32x32x16_bf16 v[112:127], v[160:163], v[16:19], v[112:127]
    v_add_f32 v171, v171, v90
    v_fmac_f32 v176, v170, v170
    v_fmac_f32 v177, v171, v171
    v_cvt_pk_bf16_f32 v21, v170, v171
    v_lshlrev_b32 v172, 16, v22
    v_and_b32 v173, 0xffff0000, v22
    v_add_f32 v172, v172, v90
    v_add_f32 v173, v173, v90
    v_fmac_f32 v176, v172, v172
    s_waitcnt lgkmcnt(6)
    v_mfma_f32_32x32x16_bf16 v[128:143], v[164:167], v[16:19], v[128:143]
    v_fmac_f32 v177, v173, v173
    v_cvt_pk_bf16_f32 v22, v172, v173
    v_lshlrev_b32 v174, 16, v23
    v_and_b32 v175, 0xffff0000, v23
    v_add_f32 v174, v174, v90
    v_add_f32 v175, v175, v90
    v_fmac_f32 v176, v174, v174
    v_fmac_f32 v177, v175, v175
    v_cvt_pk_bf16_f32 v23, v174, v175
    ds_read_b64_tr_b16 v[156:157], v83 offset:9216
    ds_read_b64_tr_b16 v[158:159], v83 offset:9984
    ds_read_b64_tr_b16 v[160:161], v83 offset:9280
    ds_read_b64_tr_b16 v[162:163], v83 offset:10048
    ds_read_b64_tr_b16 v[164:165], v83 offset:9344
    ds_read_b64_tr_b16 v[166:167], v83 offset:10112
    s_waitcnt lgkmcnt(10)
    v_mfma_f32_32x32x16_bf16 v[96:111], v[144:147], v[20:23], v[96:111]
    v_lshlrev_b32 v168, 16, v24
    v_and_b32 v169, 0xffff0000, v24
    v_add_f32 v168, v168, v90
    v_add_f32 v169, v169, v90
    v_fmac_f32 v176, v168, v168
    v_fmac_f32 v177, v169, v169
    v_cvt_pk_bf16_f32 v24, v168, v169
    v_lshlrev_b32 v170, 16, v25
    v_and_b32 v171, 0xffff0000, v25
    v_add_f32 v170, v170, v90
    s_waitcnt lgkmcnt(8)
    v_mfma_f32_32x32x16_bf16 v[112:127], v[148:151], v[20:23], v[112:127]
    v_add_f32 v171, v171, v90
    v_fmac_f32 v176, v170, v170
    v_fmac_f32 v177, v171, v171
    v_cvt_pk_bf16_f32 v25, v170, v171
    v_lshlrev_b32 v172, 16, v26
    v_and_b32 v173, 0xffff0000, v26
    v_add_f32 v172, v172, v90
    v_add_f32 v173, v173, v90
    v_fmac_f32 v176, v172, v172
    s_waitcnt lgkmcnt(6)
    v_mfma_f32_32x32x16_bf16 v[128:143], v[152:155], v[20:23], v[128:143]
    v_fmac_f32 v177, v173, v173
    v_cvt_pk_bf16_f32 v26, v172, v173
    v_lshlrev_b32 v174, 16, v27
    v_and_b32 v175, 0xffff0000, v27
    v_add_f32 v174, v174, v90
    v_add_f32 v175, v175, v90
    v_fmac_f32 v176, v174, v174
    v_fmac_f32 v177, v175, v175
    v_cvt_pk_bf16_f32 v27, v174, v175
    s_waitcnt vmcnt(6)
    s_waitcnt lgkmcnt(0)
    s_barrier
    ds_read_b64_tr_b16 v[144:145], v83 offset:12288
    ds_read_b64_tr_b16 v[146:147], v83 offset:13056
    ds_read_b64_tr_b16 v[148:149], v83 offset:12352
    ds_read_b64_tr_b16 v[150:151], v83 offset:13120
    ds_read_b64_tr_b16 v[152:153], v83 offset:12416
    ds_read_b64_tr_b16 v[154:155], v83 offset:13184
    v_mfma_f32_32x32x16_bf16 v[96:111], v[156:159], v[24:27], v[96:111]
    v_lshlrev_b32 v168, 16, v28
    v_and_b32 v169, 0xffff0000, v28
    v_add_f32 v168, v168, v90
    v_add_f32 v169, v169, v90
    v_fmac_f32 v176, v168, v168
    v_fmac_f32 v177, v169, v169
    v_cvt_pk_bf16_f32 v28, v168, v169
    v_lshlrev_b32 v170, 16, v29
    v_and_b32 v171, 0xffff0000, v29
    v_add_f32 v170, v170, v90
    v_mfma_f32_32x32x16_bf16 v[112:127], v[160:163], v[24:27], v[112:127]
    v_add_f32 v171, v171, v90
    v_fmac_f32 v176, v170, v170
    v_fmac_f32 v177, v171, v171
    v_cvt_pk_bf16_f32 v29, v170, v171
    v_lshlrev_b32 v172, 16, v30
    v_and_b32 v173, 0xffff0000, v30
    v_add_f32 v172, v172, v90
    v_add_f32 v173, v173, v90
    v_fmac_f32 v176, v172, v172
    v_mfma_f32_32x32x16_bf16 v[128:143], v[164:167], v[24:27], v[128:143]
    v_fmac_f32 v177, v173, v173
    v_cvt_pk_bf16_f32 v30, v172, v173
    v_lshlrev_b32 v174, 16, v31
    v_and_b32 v175, 0xffff0000, v31
    v_add_f32 v174, v174, v90
    v_add_f32 v175, v175, v90
    v_fmac_f32 v176, v174, v174
    v_fmac_f32 v177, v175, v175
    v_cvt_pk_bf16_f32 v31, v174, v175
    ds_read_b64_tr_b16 v[156:157], v83 offset:15360
    ds_read_b64_tr_b16 v[158:159], v83 offset:16128
    ds_read_b64_tr_b16 v[160:161], v83 offset:15424
    ds_read_b64_tr_b16 v[162:163], v83 offset:16192
    ds_read_b64_tr_b16 v[164:165], v83 offset:15488
    ds_read_b64_tr_b16 v[166:167], v83 offset:16256
    s_waitcnt lgkmcnt(10)
    v_mfma_f32_32x32x16_bf16 v[96:111], v[144:147], v[28:31], v[96:111]
    v_lshlrev_b32 v168, 16, v32
    v_and_b32 v169, 0xffff0000, v32
    v_add_f32 v168, v168, v90
    v_add_f32 v169, v169, v90
    v_fmac_f32 v176, v168, v168
    v_fmac_f32 v177, v169, v169
    v_cvt_pk_bf16_f32 v32, v168, v169
    v_lshlrev_b32 v170, 16, v33
    v_and_b32 v171, 0xffff0000, v33
    v_add_f32 v170, v170, v90
    s_waitcnt lgkmcnt(8)
    v_mfma_f32_32x32x16_bf16 v[112:127], v[148:151], v[28:31], v[112:127]
    v_add_f32 v171, v171, v90
    v_fmac_f32 v176, v170, v170
    v_fmac_f32 v177, v171, v171
    v_cvt_pk_bf16_f32 v33, v170, v171
    v_lshlrev_b32 v172, 16, v34
    v_and_b32 v173, 0xffff0000, v34
    v_add_f32 v172, v172, v90
    v_add_f32 v173, v173, v90
    v_fmac_f32 v176, v172, v172
    s_waitcnt lgkmcnt(6)
    v_mfma_f32_32x32x16_bf16 v[128:143], v[152:155], v[28:31], v[128:143]
    v_fmac_f32 v177, v173, v173
    v_cvt_pk_bf16_f32 v34, v172, v173
    v_lshlrev_b32 v174, 16, v35
    v_and_b32 v175, 0xffff0000, v35
    v_add_f32 v174, v174, v90
    v_add_f32 v175, v175, v90
    v_fmac_f32 v176, v174, v174
    v_fmac_f32 v177, v175, v175
    v_cvt_pk_bf16_f32 v35, v174, v175
    ds_read_b64_tr_b16 v[144:145], v83 offset:18432
    ds_read_b64_tr_b16 v[146:147], v83 offset:19200
    ds_read_b64_tr_b16 v[148:149], v83 offset:18496
    ds_read_b64_tr_b16 v[150:151], v83 offset:19264
    ds_read_b64_tr_b16 v[152:153], v83 offset:18560
    ds_read_b64_tr_b16 v[154:155], v83 offset:19328
    s_waitcnt lgkmcnt(10)
    v_mfma_f32_32x32x16_bf16 v[96:111], v[156:159], v[32:35], v[96:111]
    v_lshlrev_b32 v168, 16, v36
    v_and_b32 v169, 0xffff0000, v36
    v_add_f32 v168, v168, v90
    v_add_f32 v169, v169, v90
    v_fmac_f32 v176, v168, v168
    v_fmac_f32 v177, v169, v169
    v_cvt_pk_bf16_f32 v36, v168, v169
    v_lshlrev_b32 v170, 16, v37
    v_and_b32 v171, 0xffff0000, v37
    v_add_f32 v170, v170, v90
    s_waitcnt lgkmcnt(8)
    v_mfma_f32_32x32x16_bf16 v[112:127], v[160:163], v[32:35], v[112:127]
    v_add_f32 v171, v171, v90
    v_fmac_f32 v176, v170, v170
    v_fmac_f32 v177, v171, v171
    v_cvt_pk_bf16_f32 v37, v170, v171
    v_lshlrev_b32 v172, 16, v38
    v_and_b32 v173, 0xffff0000, v38
    v_add_f32 v172, v172, v90
    v_add_f32 v173, v173, v90
    v_fmac_f32 v176, v172, v172
    s_waitcnt lgkmcnt(6)
    v_mfma_f32_32x32x16_bf16 v[128:143], v[164:167], v[32:35], v[128:143]
    v_fmac_f32 v177, v173, v173
    v_cvt_pk_bf16_f32 v38, v172, v173
    v_lshlrev_b32 v174, 16, v39
    v_and_b32 v175, 0xffff0000, v39
    v_add_f32 v174, v174, v90
    v_add_f32 v175, v175, v90
    v_fmac_f32 v176, v174, v174
    v_fmac_f32 v177, v175, v175
    v_cvt_pk_bf16_f32 v39, v174, v175
    ds_read_b64_tr_b16 v[156:157], v83 offset:21504
    ds_read_b64_tr_b16 v[158:159], v83 offset:22272
    ds_read_b64_tr_b16 v[160:161], v83 offset:21568
    ds_read_b64_tr_b16 v[162:163], v83 offset:22336
    ds_read_b64_tr_b16 v[164:165], v83 offset:21632
    ds_read_b64_tr_b16 v[166:167], v83 offset:22400
    s_waitcnt lgkmcnt(10)
    v_mfma_f32_32x32x16_bf16 v[96:111], v[144:147], v[36:39], v[96:111]
    v_lshlrev_b32 v168, 16, v40
    v_and_b32 v169, 0xffff0000, v40
    v_add_f32 v168, v168, v90
    v_add_f32 v169, v169, v90
    v_fmac_f32 v176, v168, v168
    v_fmac_f32 v177, v169, v169
    v_cvt_pk_bf16_f32 v40, v168, v169
    v_lshlrev_b32 v170, 16, v41
    v_and_b32 v171, 0xffff0000, v41
    v_add_f32 v170, v170, v90
    s_waitcnt lgkmcnt(8)
    v_mfma_f32_32x32x16_bf16 v[112:127], v[148:151], v[36:39], v[112:127]
    v_add_f32 v171, v171, v90
    v_fmac_f32 v176, v170, v170
    v_fmac_f32 v177, v171, v171
    v_cvt_pk_bf16_f32 v41, v170, v171
    v_lshlrev_b32 v172, 16, v42
    v_and_b32 v173, 0xffff0000, v42
    v_add_f32 v172, v172, v90
    v_add_f32 v173, v173, v90
    v_fmac_f32 v176, v172, v172
    s_waitcnt lgkmcnt(6)
    v_mfma_f32_32x32x16_bf16 v[128:143], v[152:155], v[36:39], v[128:143]
    v_fmac_f32 v177, v173, v173
    v_cvt_pk_bf16_f32 v42, v172, v173
    v_lshlrev_b32 v174, 16, v43
    v_and_b32 v175, 0xffff0000, v43
    v_add_f32 v174, v174, v90
    v_add_f32 v175, v175, v90
    v_fmac_f32 v176, v174, v174
    v_fmac_f32 v177, v175, v175
    v_cvt_pk_bf16_f32 v43, v174, v175
    s_waitcnt vmcnt(3)
    s_waitcnt lgkmcnt(0)
    s_barrier
    ds_read_b64_tr_b16 v[144:145], v83 offset:24576
    ds_read_b64_tr_b16 v[146:147], v83 offset:25344
    ds_read_b64_tr_b16 v[148:149], v83 offset:24640
    ds_read_b64_tr_b16 v[150:151], v83 offset:25408
    ds_read_b64_tr_b16 v[152:153], v83 offset:24704
    ds_read_b64_tr_b16 v[154:155], v83 offset:25472
    v_mfma_f32_32x32x16_bf16 v[96:111], v[156:159], v[40:43], v[96:111]
    v_lshlrev_b32 v168, 16, v44
    v_and_b32 v169, 0xffff0000, v44
    v_add_f32 v168, v168, v90
    v_add_f32 v169, v169, v90
    v_fmac_f32 v176, v168, v168
    v_fmac_f32 v177, v169, v169
    v_cvt_pk_bf16_f32 v44, v168, v169
    v_lshlrev_b32 v170, 16, v45
    v_and_b32 v171, 0xffff0000, v45
    v_add_f32 v170, v170, v90
    v_mfma_f32_32x32x16_bf16 v[112:127], v[160:163], v[40:43], v[112:127]
    v_add_f32 v171, v171, v90
    v_fmac_f32 v176, v170, v170
    v_fmac_f32 v177, v171, v171
    v_cvt_pk_bf16_f32 v45, v170, v171
    v_lshlrev_b32 v172, 16, v46
    v_and_b32 v173, 0xffff0000, v46
    v_add_f32 v172, v172, v90
    v_add_f32 v173, v173, v90
    v_fmac_f32 v176, v172, v172
    v_mfma_f32_32x32x16_bf16 v[128:143], v[164:167], v[40:43], v[128:143]
    v_fmac_f32 v177, v173, v173
    v_cvt_pk_bf16_f32 v46, v172, v173
    v_lshlrev_b32 v174, 16, v47
    v_and_b32 v175, 0xffff0000, v47
    v_add_f32 v174, v174, v90
    v_add_f32 v175, v175, v90
    v_fmac_f32 v176, v174, v174
    v_fmac_f32 v177, v175, v175
    v_cvt_pk_bf16_f32 v47, v174, v175
    ds_read_b64_tr_b16 v[156:157], v83 offset:27648
    ds_read_b64_tr_b16 v[158:159], v83 offset:28416
    ds_read_b64_tr_b16 v[160:161], v83 offset:27712
    ds_read_b64_tr_b16 v[162:163], v83 offset:28480
    ds_read_b64_tr_b16 v[164:165], v83 offset:27776
    ds_read_b64_tr_b16 v[166:167], v83 offset:28544
    s_waitcnt lgkmcnt(10)
    v_mfma_f32_32x32x16_bf16 v[96:111], v[144:147], v[44:47], v[96:111]
    v_lshlrev_b32 v168, 16, v48
    v_and_b32 v169, 0xffff0000, v48
    v_add_f32 v168, v168, v90
    v_add_f32 v169, v169, v90
    v_fmac_f32 v176, v168, v168
    v_fmac_f32 v177, v169, v169
    v_cvt_pk_bf16_f32 v48, v168, v169
    v_lshlrev_b32 v170, 16, v49
    v_and_b32 v171, 0xffff0000, v49
    v_add_f32 v170, v170, v90
    s_waitcnt lgkmcnt(8)
    v_mfma_f32_32x32x16_bf16 v[112:127], v[148:151], v[44:47], v[112:127]
    v_add_f32 v171, v171, v90
    v_fmac_f32 v176, v170, v170
    v_fmac_f32 v177, v171, v171
    v_cvt_pk_bf16_f32 v49, v170, v171
    v_lshlrev_b32 v172, 16, v50
    v_and_b32 v173, 0xffff0000, v50
    v_add_f32 v172, v172, v90
    v_add_f32 v173, v173, v90
    v_fmac_f32 v176, v172, v172
    s_waitcnt lgkmcnt(6)
    v_mfma_f32_32x32x16_bf16 v[128:143], v[152:155], v[44:47], v[128:143]
    v_fmac_f32 v177, v173, v173
    v_cvt_pk_bf16_f32 v50, v172, v173
    v_lshlrev_b32 v174, 16, v51
    v_and_b32 v175, 0xffff0000, v51
    v_add_f32 v174, v174, v90
    v_add_f32 v175, v175, v90
    v_fmac_f32 v176, v174, v174
    v_fmac_f32 v177, v175, v175
    v_cvt_pk_bf16_f32 v51, v174, v175
    ds_read_b64_tr_b16 v[144:145], v83 offset:30720
    ds_read_b64_tr_b16 v[146:147], v83 offset:31488
    ds_read_b64_tr_b16 v[148:149], v83 offset:30784
    ds_read_b64_tr_b16 v[150:151], v83 offset:31552
    ds_read_b64_tr_b16 v[152:153], v83 offset:30848
    ds_read_b64_tr_b16 v[154:155], v83 offset:31616
    s_waitcnt lgkmcnt(10)
    v_mfma_f32_32x32x16_bf16 v[96:111], v[156:159], v[48:51], v[96:111]
    v_lshlrev_b32 v168, 16, v52
    v_and_b32 v169, 0xffff0000, v52
    v_add_f32 v168, v168, v90
    v_add_f32 v169, v169, v90
    v_fmac_f32 v176, v168, v168
    v_fmac_f32 v177, v169, v169
    v_cvt_pk_bf16_f32 v52, v168, v169
    v_lshlrev_b32 v170, 16, v53
    v_and_b32 v171, 0xffff0000, v53
    v_add_f32 v170, v170, v90
    s_waitcnt lgkmcnt(8)
    v_mfma_f32_32x32x16_bf16 v[112:127], v[160:163], v[48:51], v[112:127]
    v_add_f32 v171, v171, v90
    v_fmac_f32 v176, v170, v170
    v_fmac_f32 v177, v171, v171
    v_cvt_pk_bf16_f32 v53, v170, v171
    v_lshlrev_b32 v172, 16, v54
    v_and_b32 v173, 0xffff0000, v54
    v_add_f32 v172, v172, v90
    v_add_f32 v173, v173, v90
    v_fmac_f32 v176, v172, v172
    s_waitcnt lgkmcnt(6)
    v_mfma_f32_32x32x16_bf16 v[128:143], v[164:167], v[48:51], v[128:143]
    v_fmac_f32 v177, v173, v173
    v_cvt_pk_bf16_f32 v54, v172, v173
    v_lshlrev_b32 v174, 16, v55
    v_and_b32 v175, 0xffff0000, v55
    v_add_f32 v174, v174, v90
    v_add_f32 v175, v175, v90
    v_fmac_f32 v176, v174, v174
    v_fmac_f32 v177, v175, v175
    v_cvt_pk_bf16_f32 v55, v174, v175
    ds_read_b64_tr_b16 v[156:157], v83 offset:33792
    ds_read_b64_tr_b16 v[158:159], v83 offset:34560
    ds_read_b64_tr_b16 v[160:161], v83 offset:33856
    ds_read_b64_tr_b16 v[162:163], v83 offset:34624
    ds_read_b64_tr_b16 v[164:165], v83 offset:33920
    ds_read_b64_tr_b16 v[166:167], v83 offset:34688
    s_waitcnt lgkmcnt(10)
    v_mfma_f32_32x32x16_bf16 v[96:111], v[144:147], v[52:55], v[96:111]
    v_lshlrev_b32 v168, 16, v56
    v_and_b32 v169, 0xffff0000, v56
    v_add_f32 v168, v168, v90
    v_add_f32 v169, v169, v90
    v_fmac_f32 v176, v168, v168
    v_fmac_f32 v177, v169, v169
    v_cvt_pk_bf16_f32 v56, v168, v169
    v_lshlrev_b32 v170, 16, v57
    v_and_b32 v171, 0xffff0000, v57
    v_add_f32 v170, v170, v90
    s_waitcnt lgkmcnt(8)
    v_mfma_f32_32x32x16_bf16 v[112:127], v[148:151], v[52:55], v[112:127]
    v_add_f32 v171, v171, v90
    v_fmac_f32 v176, v170, v170
    v_fmac_f32 v177, v171, v171
    v_cvt_pk_bf16_f32 v57, v170, v171
    v_lshlrev_b32 v172, 16, v58
    v_and_b32 v173, 0xffff0000, v58
    v_add_f32 v172, v172, v90
    v_add_f32 v173, v173, v90
    v_fmac_f32 v176, v172, v172
    s_waitcnt lgkmcnt(6)
    v_mfma_f32_32x32x16_bf16 v[128:143], v[152:155], v[52:55], v[128:143]
    v_fmac_f32 v177, v173, v173
    v_cvt_pk_bf16_f32 v58, v172, v173
    v_lshlrev_b32 v174, 16, v59
    v_and_b32 v175, 0xffff0000, v59
    v_add_f32 v174, v174, v90
    v_add_f32 v175, v175, v90
    v_fmac_f32 v176, v174, v174
    v_fmac_f32 v177, v175, v175
    v_cvt_pk_bf16_f32 v59, v174, v175
    s_waitcnt vmcnt(0)
    s_waitcnt lgkmcnt(0)
    s_barrier
    ds_read_b64_tr_b16 v[144:145], v83 offset:36864
    ds_read_b64_tr_b16 v[146:147], v83 offset:37632
    ds_read_b64_tr_b16 v[148:149], v83 offset:36928
    ds_read_b64_tr_b16 v[150:151], v83 offset:37696
    ds_read_b64_tr_b16 v[152:153], v83 offset:36992
    ds_read_b64_tr_b16 v[154:155], v83 offset:37760
    v_mfma_f32_32x32x16_bf16 v[96:111], v[156:159], v[56:59], v[96:111]
    v_lshlrev_b32 v168, 16, v60
    v_and_b32 v169, 0xffff0000, v60
    v_add_f32 v168, v168, v90
    v_add_f32 v169, v169, v90
    v_fmac_f32 v176, v168, v168
    v_fmac_f32 v177, v169, v169
    v_cvt_pk_bf16_f32 v60, v168, v169
    v_lshlrev_b32 v170, 16, v61
    v_and_b32 v171, 0xffff0000, v61
    v_add_f32 v170, v170, v90
    v_mfma_f32_32x32x16_bf16 v[112:127], v[160:163], v[56:59], v[112:127]
    v_add_f32 v171, v171, v90
    v_fmac_f32 v176, v170, v170
    v_fmac_f32 v177, v171, v171
    v_cvt_pk_bf16_f32 v61, v170, v171
    v_lshlrev_b32 v172, 16, v62
    v_and_b32 v173, 0xffff0000, v62
    v_add_f32 v172, v172, v90
    v_add_f32 v173, v173, v90
    v_fmac_f32 v176, v172, v172
    v_mfma_f32_32x32x16_bf16 v[128:143], v[164:167], v[56:59], v[128:143]
    v_fmac_f32 v177, v173, v173
    v_cvt_pk_bf16_f32 v62, v172, v173
    v_lshlrev_b32 v174, 16, v63
    v_and_b32 v175, 0xffff0000, v63
    v_add_f32 v174, v174, v90
    v_add_f32 v175, v175, v90
    v_fmac_f32 v176, v174, v174
    v_fmac_f32 v177, v175, v175
    v_cvt_pk_bf16_f32 v63, v174, v175
    ds_read_b64_tr_b16 v[156:157], v83 offset:39936
    ds_read_b64_tr_b16 v[158:159], v83 offset:40704
    ds_read_b64_tr_b16 v[160:161], v83 offset:40000
    ds_read_b64_tr_b16 v[162:163], v83 offset:40768
    ds_read_b64_tr_b16 v[164:165], v83 offset:40064
    ds_read_b64_tr_b16 v[166:167], v83 offset:40832
    s_waitcnt lgkmcnt(10)
    v_mfma_f32_32x32x16_bf16 v[96:111], v[144:147], v[60:63], v[96:111]
    v_lshlrev_b32 v168, 16, v64
    v_and_b32 v169, 0xffff0000, v64
    v_add_f32 v168, v168, v90
    v_add_f32 v169, v169, v90
    v_fmac_f32 v176, v168, v168
    v_fmac_f32 v177, v169, v169
    v_cvt_pk_bf16_f32 v64, v168, v169
    v_lshlrev_b32 v170, 16, v65
    v_and_b32 v171, 0xffff0000, v65
    v_add_f32 v170, v170, v90
    s_waitcnt lgkmcnt(8)
    v_mfma_f32_32x32x16_bf16 v[112:127], v[148:151], v[60:63], v[112:127]
    v_add_f32 v171, v171, v90
    v_fmac_f32 v176, v170, v170
    v_fmac_f32 v177, v171, v171
    v_cvt_pk_bf16_f32 v65, v170, v171
    v_lshlrev_b32 v172, 16, v66
    v_and_b32 v173, 0xffff0000, v66
    v_add_f32 v172, v172, v90
    v_add_f32 v173, v173, v90
    v_fmac_f32 v176, v172, v172
    s_waitcnt lgkmcnt(6)
    v_mfma_f32_32x32x16_bf16 v[128:143], v[152:155], v[60:63], v[128:143]
    v_fmac_f32 v177, v173, v173
    v_cvt_pk_bf16_f32 v66, v172, v173
    v_lshlrev_b32 v174, 16, v67
    v_and_b32 v175, 0xffff0000, v67
    v_add_f32 v174, v174, v90
    v_add_f32 v175, v175, v90
    v_fmac_f32 v176, v174, v174
    v_fmac_f32 v177, v175, v175
    v_cvt_pk_bf16_f32 v67, v174, v175
    ds_read_b64_tr_b16 v[144:145], v83 offset:43008
    ds_read_b64_tr_b16 v[146:147], v83 offset:43776
    ds_read_b64_tr_b16 v[148:149], v83 offset:43072
    ds_read_b64_tr_b16 v[150:151], v83 offset:43840
    ds_read_b64_tr_b16 v[152:153], v83 offset:43136
    ds_read_b64_tr_b16 v[154:155], v83 offset:43904
    s_waitcnt lgkmcnt(10)
    v_mfma_f32_32x32x16_bf16 v[96:111], v[156:159], v[64:67], v[96:111]
    v_lshlrev_b32 v168, 16, v68
    v_and_b32 v169, 0xffff0000, v68
    v_add_f32 v168, v168, v90
    v_add_f32 v169, v169, v90
    v_fmac_f32 v176, v168, v168
    v_fmac_f32 v177, v169, v169
    v_cvt_pk_bf16_f32 v68, v168, v169
    v_lshlrev_b32 v170, 16, v69
    v_and_b32 v171, 0xffff0000, v69
    v_add_f32 v170, v170, v90
    s_waitcnt lgkmcnt(8)
    v_mfma_f32_32x32x16_bf16 v[112:127], v[160:163], v[64:67], v[112:127]
    v_add_f32 v171, v171, v90
    v_fmac_f32 v176, v170, v170
    v_fmac_f32 v177, v171, v171
    v_cvt_pk_bf16_f32 v69, v170, v171
    v_lshlrev_b32 v172, 16, v70
    v_and_b32 v173, 0xffff0000, v70
    v_add_f32 v172, v172, v90
    v_add_f32 v173, v173, v90
    v_fmac_f32 v176, v172, v172
    s_waitcnt lgkmcnt(6)
    v_mfma_f32_32x32x16_bf16 v[128:143], v[164:167], v[64:67], v[128:143]
    v_fmac_f32 v177, v173, v173
    v_cvt_pk_bf16_f32 v70, v172, v173
    v_lshlrev_b32 v174, 16, v71
    v_and_b32 v175, 0xffff0000, v71
    v_add_f32 v174, v174, v90
    v_add_f32 v175, v175, v90
    v_fmac_f32 v176, v174, v174
    v_fmac_f32 v177, v175, v175
    v_cvt_pk_bf16_f32 v71, v174, v175
    ds_read_b64_tr_b16 v[156:157], v83 offset:46080
    ds_read_b64_tr_b16 v[158:159], v83 offset:46848
    ds_read_b64_tr_b16 v[160:161], v83 offset:46144
    ds_read_b64_tr_b16 v[162:163], v83 offset:46912
    ds_read_b64_tr_b16 v[164:165], v83 offset:46208
    ds_read_b64_tr_b16 v[166:167], v83 offset:46976
    s_waitcnt lgkmcnt(10)
    v_mfma_f32_32x32x16_bf16 v[96:111], v[144:147], v[68:71], v[96:111]
    v_lshlrev_b32 v168, 16, v72
    v_and_b32 v169, 0xffff0000, v72
    v_add_f32 v168, v168, v90
    v_add_f32 v169, v169, v90
    v_fmac_f32 v176, v168, v168
    v_fmac_f32 v177, v169, v169
    v_cvt_pk_bf16_f32 v72, v168, v169
    v_lshlrev_b32 v170, 16, v73
    v_and_b32 v171, 0xffff0000, v73
    v_add_f32 v170, v170, v90
    s_waitcnt lgkmcnt(8)
    v_mfma_f32_32x32x16_bf16 v[112:127], v[148:151], v[68:71], v[112:127]
    v_add_f32 v171, v171, v90
    v_fmac_f32 v176, v170, v170
    v_fmac_f32 v177, v171, v171
    v_cvt_pk_bf16_f32 v73, v170, v171
    v_lshlrev_b32 v172, 16, v74
    v_and_b32 v173, 0xffff0000, v74
    v_add_f32 v172, v172, v90
    v_add_f32 v173, v173, v90
    v_fmac_f32 v176, v172, v172
    s_waitcnt lgkmcnt(6)
    v_mfma_f32_32x32x16_bf16 v[128:143], v[152:155], v[68:71], v[128:143]
    v_fmac_f32 v177, v173, v173
    v_cvt_pk_bf16_f32 v74, v172, v173
    v_lshlrev_b32 v174, 16, v75
    v_and_b32 v175, 0xffff0000, v75
    v_add_f32 v174, v174, v90
    v_add_f32 v175, v175, v90
    v_fmac_f32 v176, v174, v174
    v_fmac_f32 v177, v175, v175
    v_cvt_pk_bf16_f32 v75, v174, v175
    s_waitcnt lgkmcnt(4)
    s_nop 0
    v_mfma_f32_32x32x16_bf16 v[96:111], v[156:159], v[72:75], v[96:111]
    s_waitcnt lgkmcnt(2)
    v_mfma_f32_32x32x16_bf16 v[112:127], v[160:163], v[72:75], v[112:127]
    s_waitcnt lgkmcnt(0)
    v_mfma_f32_32x32x16_bf16 v[128:143], v[164:167], v[72:75], v[128:143]
    v_add_f32 v176, v176, v177
    v_mov_b32 v2, v176
    v_mov_b32 v3, v176
    s_nop 1
    v_permlane32_swap_b32 v2, v3
    v_add_f32 v176, v2, v3
    v_lshlrev_b32 v182, 4, v1
    s_mul_i32 s27, s33, 13312
    s_add_u32 s27, s27, 98304
    v_add_u32 v182, s27, v182
    s_nop 1
    s_cmp_eq_u32 s34, 0
    s_cbranch_scc1 L_k1_comb0
    ds_write_b128 v182, v[96:99] offset:0
    ds_write_b128 v182, v[100:103] offset:1024
    ds_write_b128 v182, v[104:107] offset:2048
    ds_write_b128 v182, v[108:111] offset:3072
    ds_write_b128 v182, v[112:115] offset:4096
    ds_write_b128 v182, v[116:119] offset:5120
    ds_write_b128 v182, v[120:123] offset:6144
    ds_write_b128 v182, v[124:127] offset:7168
    ds_write_b128 v182, v[128:131] offset:8192
    ds_write_b128 v182, v[132:135] offset:9216
    ds_write_b128 v182, v[136:139] offset:10240
    ds_write_b128 v182, v[140:143] offset:11264
    ds_write_b128 v182, v[176:179] offset:12288
    s_waitcnt lgkmcnt(0)
    s_barrier
    s_branch L_k1_end
L_k1_comb0:
    s_barrier
    ds_read_b128 v[12:15], v182 offset:0
    ds_read_b128 v[16:19], v182 offset:1024
    ds_read_b128 v[20:23], v182 offset:2048
    ds_read_b128 v[24:27], v182 offset:3072
    ds_read_b128 v[28:31], v182 offset:4096
    ds_read_b128 v[32:35], v182 offset:5120
    ds_read_b128 v[36:39], v182 offset:6144
    ds_read_b128 v[40:43], v182 offset:7168
    ds_read_b128 v[44:47], v182 offset:8192
    ds_read_b128 v[48:51], v182 offset:9216
    ds_read_b128 v[52:55], v182 offset:10240
    ds_read_b128 v[56:59], v182 offset:11264
    ds_read_b128 v[60:63], v182 offset:12288
    s_waitcnt lgkmcnt(12)
    v_add_f32 v96, v96, v12
    v_add_f32 v97, v97, v13
    v_add_f32 v98, v98, v14
    v_add_f32 v99, v99, v15
    s_waitcnt lgkmcnt(11)
    v_add_f32 v100, v100, v16
    v_add_f32 v101, v101, v17
    v_add_f32 v102, v102, v18
    v_add_f32 v103, v103, v19
    s_waitcnt lgkmcnt(10)
    v_add_f32 v104, v104, v20
    v_add_f32 v105, v105, v21
    v_add_f32 v106, v106, v22
    v_add_f32 v107, v107, v23
    s_waitcnt lgkmcnt(9)
    v_add_f32 v108, v108, v24
    v_add_f32 v109, v109, v25
    v_add_f32 v110, v110, v26
    v_add_f32 v111, v111, v27
    s_waitcnt lgkmcnt(8)
    v_add_f32 v112, v112, v28
    v_add_f32 v113, v113, v29
    v_add_f32 v114, v114, v30
    v_add_f32 v115, v115, v31
    s_waitcnt lgkmcnt(7)
    v_add_f32 v116, v116, v32
    v_add_f32 v117, v117, v33
    v_add_f32 v118, v118, v34
    v_add_f32 v119, v119, v35
    s_waitcnt lgkmcnt(6)
    v_add_f32 v120, v120, v36
    v_add_f32 v121, v121, v37
    v_add_f32 v122, v122, v38
    v_add_f32 v123, v123, v39
    s_waitcnt lgkmcnt(5)
    v_add_f32 v124, v124, v40
    v_add_f32 v125, v125, v41
    v_add_f32 v126, v126, v42
    v_add_f32 v127, v127, v43
    s_waitcnt lgkmcnt(4)
    v_add_f32 v128, v128, v44
    v_add_f32 v129, v129, v45
    v_add_f32 v130, v130, v46
    v_add_f32 v131, v131, v47
    s_waitcnt lgkmcnt(3)
    v_add_f32 v132, v132, v48
    v_add_f32 v133, v133, v49
    v_add_f32 v134, v134, v50
    v_add_f32 v135, v135, v51
    s_waitcnt lgkmcnt(2)
    v_add_f32 v136, v136, v52
    v_add_f32 v137, v137, v53
    v_add_f32 v138, v138, v54
    v_add_f32 v139, v139, v55
    s_waitcnt lgkmcnt(1)
    v_add_f32 v140, v140, v56
    v_add_f32 v141, v141, v57
    v_add_f32 v142, v142, v58
    v_add_f32 v143, v143, v59
    s_waitcnt lgkmcnt(0)
    v_add_f32 v180, v176, v60
    v_mul_f32 v180, 0x3b000000, v180
    v_fma_f32 v180, -v91, v91, v180
    v_max_f32 v180, 0, v180
    v_cvt_pk_bf16_f32 v2, v180, v180
    v_and_b32 v180, 0xffff0000, v2
    v_add_f32 v180, 0x3727c5ac, v180
    v_cvt_pk_bf16_f32 v2, v180, v180
    v_and_b32 v180, 0xffff0000, v2
    v_sqrt_f32 v180, v180
    s_nop 0
    v_cvt_pk_bf16_f32 v2, v180, v180
    v_and_b32 v180, 0xffff0000, v2
    v_rcp_f32 v181, v180
    s_mul_i32 s27, s25, 6
    s_add_u32 s28, s27, 0
    s_cmp_lt_u32 s28, 32
    s_cselect_b32 s36, 0x3eb8aa3b, 1.0
    s_lshl_b32 s40, s28, 16
    s_add_u32 s41, s40, 65536
    s_add_u32 s28, s27, 2
    s_cmp_lt_u32 s28, 32
    s_cselect_b32 s37, 0x3eb8aa3b, 1.0
    s_lshl_b32 s42, s28, 16
    s_add_u32 s43, s42, 65536
    s_add_u32 s28, s27, 4
    s_cmp_lt_u32 s28, 32
    s_cselect_b32 s38, 0x3eb8aa3b, 1.0
    s_lshl_b32 s44, s28, 16
    s_add_u32 s45, s44, 65536
    v_lshlrev_b32 v183, 5, v5
    v_lshl_add_u32 v183, v4, 4, v183
    s_mov_b32 s20, s8
    s_mov_b32 s21, s9
    s_and_b32 s21, s21, 0xffff
    s_mov_b32 s22, 6291456
    s_mov_b32 s23, 0x00020000
    v_mul_f32 v184, s36, v181
    v_mul_f32 v96, v96, v184
    v_mul_f32 v97, v97, v184
    v_mul_f32 v98, v98, v184
    v_mul_f32 v99, v99, v184
    v_mul_f32 v100, v100, v184
    v_mul_f32 v101, v101, v184
    v_mul_f32 v102, v102, v184
    v_mul_f32 v103, v103, v184
    v_mul_f32 v104, v104, v184
    v_mul_f32 v105, v105, v184
    v_mul_f32 v106, v106, v184
    v_mul_f32 v107, v107, v184
    v_mul_f32 v108, v108, v184
    v_mul_f32 v109, v109, v184
    v_mul_f32 v110, v110, v184
    v_mul_f32 v111, v111, v184
    v_cvt_pk_bf16_f32 v12, v96, v97
    v_cvt_pk_bf16_f32 v13, v98, v99
    v_cvt_pk_bf16_f32 v14, v100, v101
    v_cvt_pk_bf16_f32 v15, v102, v103
    v_cvt_pk_bf16_f32 v16, v104, v105
    v_cvt_pk_bf16_f32 v17, v106, v107
    v_cvt_pk_bf16_f32 v18, v108, v109
    v_cvt_pk_bf16_f32 v19, v110, v111
    buffer_store_dwordx4 v[12:15], v183, s[20:23], s40 offen
    buffer_store_dwordx4 v[16:19], v183, s[20:23], s41 offen
    v_mul_f32 v184, s37, v181
    v_mul_f32 v112, v112, v184
    v_mul_f32 v113, v113, v184
    v_mul_f32 v114, v114, v184
    v_mul_f32 v115, v115, v184
    v_mul_f32 v116, v116, v184
    v_mul_f32 v117, v117, v184
    v_mul_f32 v118, v118, v184
    v_mul_f32 v119, v119, v184
    v_mul_f32 v120, v120, v184
    v_mul_f32 v121, v121, v184
    v_mul_f32 v122, v122, v184
    v_mul_f32 v123, v123, v184
    v_mul_f32 v124, v124, v184
    v_mul_f32 v125, v125, v184
    v_mul_f32 v126, v126, v184
    v_mul_f32 v127, v127, v184
    v_cvt_pk_bf16_f32 v20, v112, v113
    v_cvt_pk_bf16_f32 v21, v114, v115
    v_cvt_pk_bf16_f32 v22, v116, v117
    v_cvt_pk_bf16_f32 v23, v118, v119
    v_cvt_pk_bf16_f32 v24, v120, v121
    v_cvt_pk_bf16_f32 v25, v122, v123
    v_cvt_pk_bf16_f32 v26, v124, v125
    v_cvt_pk_bf16_f32 v27, v126, v127
    buffer_store_dwordx4 v[20:23], v183, s[20:23], s42 offen
    buffer_store_dwordx4 v[24:27], v183, s[20:23], s43 offen
    v_mul_f32 v184, s38, v181
    v_mul_f32 v128, v128, v184
    v_mul_f32 v129, v129, v184
    v_mul_f32 v130, v130, v184
    v_mul_f32 v131, v131, v184
    v_mul_f32 v132, v132, v184
    v_mul_f32 v133, v133, v184
    v_mul_f32 v134, v134, v184
    v_mul_f32 v135, v135, v184
    v_mul_f32 v136, v136, v184
    v_mul_f32 v137, v137, v184
    v_mul_f32 v138, v138, v184
    v_mul_f32 v139, v139, v184
    v_mul_f32 v140, v140, v184
    v_mul_f32 v141, v141, v184
    v_mul_f32 v142, v142, v184
    v_mul_f32 v143, v143, v184
    v_cvt_pk_bf16_f32 v28, v128, v129
    v_cvt_pk_bf16_f32 v29, v130, v131
    v_cvt_pk_bf16_f32 v30, v132, v133
    v_cvt_pk_bf16_f32 v31, v134, v135
    v_cvt_pk_bf16_f32 v32, v136, v137
    v_cvt_pk_bf16_f32 v33, v138, v139
    v_cvt_pk_bf16_f32 v34, v140, v141
    v_cvt_pk_bf16_f32 v35, v142, v143
    buffer_store_dwordx4 v[28:31], v183, s[20:23], s44 offen
    buffer_store_dwordx4 v[32:35], v183, s[20:23], s45 offen
    s_waitcnt vmcnt(0)
L_k1_end:
    s_endpgm
k1_lnqkv_kernel_codeend:
.section .rodata,"a"
.p2align 6
.amdhsa_kernel k1_lnqkv_kernel
  .amdhsa_next_free_vgpr 192
  .amdhsa_next_free_sgpr 56
  .amdhsa_accum_offset 192
  .amdhsa_group_segment_fixed_size 0
  .amdhsa_kernarg_size 80
  .amdhsa_user_sgpr_count 2
  .amdhsa_user_sgpr_kernarg_segment_ptr 1
  .amdhsa_system_sgpr_workgroup_id_x 1
.end_amdhsa_kernel
.text
.globl k2_attn_kernel
.p2align 8
.type k2_attn_kernel,@function
k2_attn_kernel:

    s_cmp_ge_u32 s2, 256
    s_cbranch_scc1 L_k2_end
    s_load_dwordx2 s[4:5], s[0:1], 72
    s_load_dwordx2 s[36:37], s[0:1], 16
    s_load_dwordx4 s[44:47], s[0:1], 32
    v_and_b32 v1, 63, v0
    v_lshrrev_b32 v2, 6, v0
    s_nop 0
    v_readfirstlane_b32 s18, v2
    s_and_b32 s16, s2, 31
    s_lshr_b32 s17, s2, 5
    s_nop 1
    s_and_b32 s19, s18, 7
    s_lshr_b32 s20, s18, 3
    v_and_b32 v2, 31, v1
    v_lshlrev_b32 v5, 5, v2
    v_lshrrev_b32 v3, 5, v1
    v_lshl_add_u32 v5, v3, 4, v5
    s_waitcnt lgkmcnt(0)
    s_mov_b32 s8, s4
    s_mov_b32 s9, s5
    s_and_b32 s9, s9, 0xffff
    s_mov_b32 s10, 6291456
    s_mov_b32 s11, 0x00020000
    s_lshl_b32 s21, s17, 3
    s_add_u32 s21, s21, s19
    s_lshl_b32 s22, s21, 10
    s_lshl_b32 s26, s16, 16
    s_add_u32 s22, s22, s26
    buffer_load_dwordx4 v[8:11], v5, s[8:11], s22 offen
    s_mov_b32 s27, s21
    v_lshlrev_b32 v12, 4, v1
    s_lshr_b32 s21, s18, 2
    s_and_b32 s21, s21, 1
    s_and_b32 s22, s18, 3
    s_lshl_b32 s25, s20, 5
    s_add_u32 s25, s25, s22
    s_lshl_b32 s25, s25, 10
    s_lshl_b32 s22, s21, 16
    s_add_u32 s25, s25, s22
    s_add_u32 s23, s16, 32
    s_lshl_b32 s23, s23, 16
    s_lshl_b32 s22, s21, 21
    s_add_u32 s23, s23, s22
    s_and_b32 s22, s25, 0xffff
    s_add_u32 s23, s23, s22
    s_mov_b32 s28, s23
    s_add_u32 m0, s25, 0
    s_add_u32 s29, s28, 0
    buffer_load_dwordx4 v12, s[8:11], s29 offen lds
    v_mov_b32 v2, 0x3f803f80
    v_mov_b32 v3, 0x3f803f80
    v_lshlrev_b32 v4, 3, v0
    v_add_u32 v4, 131072, v4
    v_and_b32 v2, 2, v0
    v_cmp_eq_u32 vcc, 0, v2
    v_mov_b32 v14, 0
    v_mov_b32 v3, 0x3f80
    v_mov_b32 v15, 0
    v_cndmask_b32 v14, v14, v3, vcc
    ds_write_b64 v4, v[14:15]
    s_lshl_b32 s22, s20, 15
    v_add_u32 v16, s22, v5
    v_and_b32 v2, 15, v1
    v_lshlrev_b32 v2, 3, v2
    v_lshrrev_b32 v3, 5, v1
    v_lshl_add_u32 v17, v3, 7, v2
    s_add_u32 s22, s22, 65536
    v_add_u32 v17, s22, v17
    v_xor_b32 v3, 1, v3
    v_lshl_add_u32 v4, v3, 7, v2
    v_add_u32 v4, 131072, v4
    v_and_b32 v2, 16, v1
    v_cmp_ne_u32 vcc, 0, v2
    s_nop 1
    v_cndmask_b32 v17, v17, v4, vcc
    v_mov_b32 v18, 4096
    v_mov_b32 v2, 0
    v_mov_b32 v3, 4096
    v_cndmask_b32 v18, v3, v2, vcc
    s_add_u32 m0, s25, 4096
    s_add_u32 s29, s28, 4096
    buffer_load_dwordx4 v12, s[8:11], s29 offen lds
    s_add_u32 m0, s25, 8192
    s_add_u32 s29, s28, 8192
    buffer_load_dwordx4 v12, s[8:11], s29 offen lds
    s_add_u32 m0, s25, 12288
    s_add_u32 s29, s28, 12288
    buffer_load_dwordx4 v12, s[8:11], s29 offen lds
    s_add_u32 m0, s25, 16384
    s_add_u32 s29, s28, 16384
    buffer_load_dwordx4 v12, s[8:11], s29 offen lds
    s_add_u32 m0, s25, 20480
    s_add_u32 s29, s28, 20480
    buffer_load_dwordx4 v12, s[8:11], s29 offen lds
    s_add_u32 m0, s25, 24576
    s_add_u32 s29, s28, 24576
    buffer_load_dwordx4 v12, s[8:11], s29 offen lds
    s_add_u32 m0, s25, 28672
    s_add_u32 s29, s28, 28672
    buffer_load_dwordx4 v12, s[8:11], s29 offen lds
    s_waitcnt vmcnt(7)
    s_waitcnt lgkmcnt(0)
    s_barrier
    ds_read_b128 v[20:23], v5 offset:0
    s_waitcnt lgkmcnt(0)
    v_mfma_f32_32x32x16_bf16 v[36:51], v[20:23], v[8:11], 0
    s_nop 11
    v_max3_f32 v108, v36, v37, v38
    v_max3_f32 v108, v108, v39, v40
    v_max3_f32 v108, v108, v41, v42
    v_max3_f32 v108, v108, v43, v44
    v_max3_f32 v108, v108, v45, v46
    v_max3_f32 v108, v108, v47, v48
    v_max3_f32 v108, v108, v49, v50
    v_max_f32 v108, v108, v51
    v_mov_b32 v2, v108
    v_mov_b32 v3, v108
    s_nop 1
    v_permlane32_swap_b32 v2, v3
    v_max_f32 v108, v2, v3
    v_xor_b32 v92, 0x80000000, v108
    v_mov_b32 v93, v92
    v_mov_b32 v94, v92
    v_mov_b32 v95, v92
    v_mov_b32 v96, v92
    v_mov_b32 v97, v92
    v_mov_b32 v98, v92
    v_mov_b32 v99, v92
    v_mov_b32 v100, v92
    v_mov_b32 v101, v92
    v_mov_b32 v102, v92
    v_mov_b32 v103, v92
    v_mov_b32 v104, v92
    v_mov_b32 v105, v92
    v_mov_b32 v106, v92
    v_mov_b32 v107, v92
    v_mov_b32 v76, 0
    v_mov_b32 v77, 0
    v_mov_b32 v78, 0
    v_mov_b32 v79, 0
    v_mov_b32 v80, 0
    v_mov_b32 v81, 0
    v_mov_b32 v82, 0
    v_mov_b32 v83, 0
    v_mov_b32 v84, 0
    v_mov_b32 v85, 0
    v_mov_b32 v86, 0
    v_mov_b32 v87, 0
    v_mov_b32 v88, 0
    v_mov_b32 v89, 0
    v_mov_b32 v90, 0
    v_mov_b32 v91, 0
    ds_read_b128 v[20:23], v16 offset:0
    ds_read_b128 v[24:27], v16 offset:1024
    s_waitcnt lgkmcnt(1)
    v_mfma_f32_32x32x16_bf16 v[36:51], v[20:23], v[8:11], v[92:107]
    s_mov_b32 s24, 0
    s_waitcnt lgkmcnt(0)
    s_nop 9
L_k2_loop:
    ds_read_b128 v[20:23], v16 offset:2048
    ds_read_b64_tr_b16 v[28:29], v17 offset:0
    ds_read_b64_tr_b16 v[30:31], v17 offset:256
    ds_read_b64_tr_b16 v[32:33], v17 offset:512
    ds_read_b64_tr_b16 v[34:35], v17 offset:768
    v_mfma_f32_32x32x16_bf16 v[52:67], v[24:27], v[8:11], v[92:107]
    v_exp_f32 v36, v36
    v_exp_f32 v37, v37
    v_exp_f32 v38, v38
    v_exp_f32 v39, v39
    v_exp_f32 v40, v40
    v_exp_f32 v41, v41
    v_exp_f32 v42, v42
    v_exp_f32 v43, v43
    v_cvt_pk_bf16_f32 v68, v36, v37
    v_cvt_pk_bf16_f32 v69, v38, v39
    v_cvt_pk_bf16_f32 v70, v40, v41
    v_cvt_pk_bf16_f32 v71, v42, v43
    s_waitcnt lgkmcnt(2)
    s_nop 0
    v_mfma_f32_32x32x16_bf16 v[76:91], v[28:31], v[68:71], v[76:91]
    v_exp_f32 v44, v44
    v_exp_f32 v45, v45
    v_exp_f32 v46, v46
    v_exp_f32 v47, v47
    v_exp_f32 v48, v48
    v_exp_f32 v49, v49
    v_exp_f32 v50, v50
    v_exp_f32 v51, v51
    v_cvt_pk_bf16_f32 v72, v44, v45
    v_cvt_pk_bf16_f32 v73, v46, v47
    v_cvt_pk_bf16_f32 v74, v48, v49
    v_cvt_pk_bf16_f32 v75, v50, v51
    s_waitcnt lgkmcnt(0)
    s_nop 0
    v_mfma_f32_32x32x16_bf16 v[76:91], v[32:35], v[72:75], v[76:91]
    ds_read_b128 v[24:27], v16 offset:3072
    ds_read_b64_tr_b16 v[28:29], v17 offset:1024
    ds_read_b64_tr_b16 v[30:31], v17 offset:1280
    ds_read_b64_tr_b16 v[32:33], v17 offset:1536
    ds_read_b64_tr_b16 v[34:35], v17 offset:1792
    v_mfma_f32_32x32x16_bf16 v[36:51], v[20:23], v[8:11], v[92:107]
    v_exp_f32 v52, v52
    v_exp_f32 v53, v53
    v_exp_f32 v54, v54
    v_exp_f32 v55, v55
    v_exp_f32 v56, v56
    v_exp_f32 v57, v57
    v_exp_f32 v58, v58
    v_exp_f32 v59, v59
    v_cvt_pk_bf16_f32 v68, v52, v53
    v_cvt_pk_bf16_f32 v69, v54, v55
    v_cvt_pk_bf16_f32 v70, v56, v57
    v_cvt_pk_bf16_f32 v71, v58, v59
    s_waitcnt lgkmcnt(2)
    s_nop 0
    v_mfma_f32_32x32x16_bf16 v[76:91], v[28:31], v[68:71], v[76:91]
    v_exp_f32 v60, v60
    v_exp_f32 v61, v61
    v_exp_f32 v62, v62
    v_exp_f32 v63, v63
    v_exp_f32 v64, v64
    v_exp_f32 v65, v65
    v_exp_f32 v66, v66
    v_exp_f32 v67, v67
    v_cvt_pk_bf16_f32 v72, v60, v61
    v_cvt_pk_bf16_f32 v73, v62, v63
    v_cvt_pk_bf16_f32 v74, v64, v65
    v_cvt_pk_bf16_f32 v75, v66, v67
    s_waitcnt lgkmcnt(0)
    s_nop 0
    v_mfma_f32_32x32x16_bf16 v[76:91], v[32:35], v[72:75], v[76:91]
    s_cmp_lg_u32 s24, 0
    s_cbranch_scc1 L_k2_nosync
    s_waitcnt vmcnt(0)
    s_barrier
L_k2_nosync:
    ds_read_b128 v[20:23], v16 offset:4096
    ds_read_b64_tr_b16 v[28:29], v17 offset:2048
    ds_read_b64_tr_b16 v[30:31], v17 offset:2304
    ds_read_b64_tr_b16 v[32:33], v17 offset:2560
    ds_read_b64_tr_b16 v[34:35], v17 offset:2816
    v_mfma_f32_32x32x16_bf16 v[52:67], v[24:27], v[8:11], v[92:107]
    v_exp_f32 v36, v36
    v_exp_f32 v37, v37
    v_exp_f32 v38, v38
    v_exp_f32 v39, v39
    v_exp_f32 v40, v40
    v_exp_f32 v41, v41
    v_exp_f32 v42, v42
    v_exp_f32 v43, v43
    v_cvt_pk_bf16_f32 v68, v36, v37
    v_cvt_pk_bf16_f32 v69, v38, v39
    v_cvt_pk_bf16_f32 v70, v40, v41
    v_cvt_pk_bf16_f32 v71, v42, v43
    s_waitcnt lgkmcnt(2)
    s_nop 0
    v_mfma_f32_32x32x16_bf16 v[76:91], v[28:31], v[68:71], v[76:91]
    v_exp_f32 v44, v44
    v_exp_f32 v45, v45
    v_exp_f32 v46, v46
    v_exp_f32 v47, v47
    v_exp_f32 v48, v48
    v_exp_f32 v49, v49
    v_exp_f32 v50, v50
    v_exp_f32 v51, v51
    v_cvt_pk_bf16_f32 v72, v44, v45
    v_cvt_pk_bf16_f32 v73, v46, v47
    v_cvt_pk_bf16_f32 v74, v48, v49
    v_cvt_pk_bf16_f32 v75, v50, v51
    s_waitcnt lgkmcnt(0)
    s_nop 0
    v_mfma_f32_32x32x16_bf16 v[76:91], v[32:35], v[72:75], v[76:91]
    ds_read_b128 v[24:27], v16 offset:5120
    ds_read_b64_tr_b16 v[28:29], v17 offset:3072
    ds_read_b64_tr_b16 v[30:31], v17 offset:3328
    ds_read_b64_tr_b16 v[32:33], v17 offset:3584
    ds_read_b64_tr_b16 v[34:35], v17 offset:3840
    v_mfma_f32_32x32x16_bf16 v[36:51], v[20:23], v[8:11], v[92:107]
    v_exp_f32 v52, v52
    v_exp_f32 v53, v53
    v_exp_f32 v54, v54
    v_exp_f32 v55, v55
    v_exp_f32 v56, v56
    v_exp_f32 v57, v57
    v_exp_f32 v58, v58
    v_exp_f32 v59, v59
    v_cvt_pk_bf16_f32 v68, v52, v53
    v_cvt_pk_bf16_f32 v69, v54, v55
    v_cvt_pk_bf16_f32 v70, v56, v57
    v_cvt_pk_bf16_f32 v71, v58, v59
    s_waitcnt lgkmcnt(2)
    s_nop 0
    v_mfma_f32_32x32x16_bf16 v[76:91], v[28:31], v[68:71], v[76:91]
    v_exp_f32 v60, v60
    v_exp_f32 v61, v61
    v_exp_f32 v62, v62
    v_exp_f32 v63, v63
    v_exp_f32 v64, v64
    v_exp_f32 v65, v65
    v_exp_f32 v66, v66
    v_exp_f32 v67, v67
    v_cvt_pk_bf16_f32 v72, v60, v61
    v_cvt_pk_bf16_f32 v73, v62, v63
    v_cvt_pk_bf16_f32 v74, v64, v65
    v_cvt_pk_bf16_f32 v75, v66, v67
    s_waitcnt lgkmcnt(0)
    s_nop 0
    v_mfma_f32_32x32x16_bf16 v[76:91], v[32:35], v[72:75], v[76:91]
    v_add_u32 v16, 4096, v16
    v_add_u32 v17, v18, v17
    s_add_u32 s24, s24, 1
    s_cmp_lt_u32 s24, 8
    s_cbranch_scc1 L_k2_loop
    s_cmp_gt_u32 s18, 13
    s_cbranch_scc1 L_k2_nopf
    s_cmp_lt_u32 s18, 10
    s_cbranch_scc1 L_k2_pfw
    s_sub_u32 s21, s18, 10
    s_lshl_b32 s21, s21, 13
    s_getpc_b64 s[48:49]
L_k2_pc:
    s_add_u32 s48, s48, k3_oproj_kernel-L_k2_pc
    s_addc_u32 s49, s49, 0
    v_lshlrev_b32 v2, 7, v1
    v_add_u32 v2, s21, v2
    v_min_u32 v2, k5_down_kernel_codeend-k3_oproj_kernel-4, v2
    global_load_dword v109, v2, s[48:49]
    s_branch L_k2_nopf
L_k2_pfw:
    s_lshr_b32 s21, s2, 3
    s_cmp_gt_u32 s18, 1
    s_cbranch_scc1 L_k2_pf2
    s_mov_b32 s40, s36
    s_mov_b32 s41, s37
    s_and_b32 s41, s41, 0xffff
    s_mov_b32 s42, 524288
    s_mov_b32 s43, 0x00020000
    s_lshl_b32 s21, s21, 14
    s_lshl_b32 s22, s18, 9
    s_add_u32 s21, s21, s22
    v_and_b32 v2, 15, v1
    v_mul_u32_u24 v2, 1024, v2
    v_lshrrev_b32 v3, 4, v1
    v_lshl_add_u32 v2, v3, 7, v2
    s_waitcnt vmcnt(0)
    buffer_load_dword v109, v2, s[40:43], s21 offen offset:0
    s_branch L_k2_nopf
L_k2_pf2:
    s_sub_u32 s22, s18, 2
    s_cmp_ge_u32 s22, 4
    s_cselect_b32 s44, s46, s44
    s_cselect_b32 s45, s47, s45
    s_mov_b32 s40, s44
    s_mov_b32 s41, s45
    s_and_b32 s41, s41, 0xffff
    s_mov_b32 s42, 1835008
    s_mov_b32 s43, 0x00020000
    s_and_b32 s22, s22, 3
    s_lshl_b32 s22, s22, 9
    s_mul_i32 s21, s21, 57344
    s_add_u32 s21, s21, s22
    s_bfe_u32 s22, s2, 0x10002
    s_mul_i32 s22, s22, 1792
    s_add_u32 s21, s21, s22
    v_and_b32 v2, 15, v1
    v_mul_u32_u24 v2, 3584, v2
    v_lshrrev_b32 v3, 4, v1
    v_lshl_add_u32 v2, v3, 7, v2
    s_waitcnt vmcnt(0)
    buffer_load_dword v109, v2, s[40:43], s21 offen offset:0
L_k2_nopf:
    s_mul_i32 s21, s19, 3072
    s_add_u32 s21, s21, 139264
    v_add_u32 v110, s21, v12
    s_nop 1
    s_cmp_eq_u32 s20, 0
    s_cbranch_scc1 L_k2_comb0
    ds_write_b128 v110, v[76:79] offset:0
    ds_write_b128 v110, v[80:83] offset:1024
    ds_write_b128 v110, v[84:87] offset:2048
    s_waitcnt lgkmcnt(0)
    s_barrier
    s_branch L_k2_end
L_k2_comb0:
    s_barrier
    ds_read_b128 v[36:39], v110 offset:0
    ds_read_b128 v[40:43], v110 offset:1024
    ds_read_b128 v[44:47], v110 offset:2048
    s_waitcnt lgkmcnt(2)
    v_add_f32 v76, v76, v36
    v_add_f32 v77, v77, v37
    v_add_f32 v78, v78, v38
    v_add_f32 v79, v79, v39
    s_waitcnt lgkmcnt(1)
    v_add_f32 v80, v80, v40
    v_add_f32 v81, v81, v41
    v_add_f32 v82, v82, v42
    v_add_f32 v83, v83, v43
    s_waitcnt lgkmcnt(0)
    v_add_f32 v84, v84, v44
    v_max3_f32 v2, |v76|, |v77|, |v78|
    v_max3_f32 v2, v2, |v79|, |v80|
    v_max3_f32 v2, v2, |v81|, |v82|
    v_max_f32 v2, v2, |v83|
    v_mov_b32 v3, 0x71800000
    v_mov_b32 v4, 0x7f000000
    v_cmp_nlt_f32 s[28:29], v84, v3
    v_cmp_nlt_f32 s[30:31], v2, v4
    s_nop 3
    s_or_b64 s[28:29], s[28:29], s[30:31]
    s_cmp_eq_u64 s[28:29], 0
    s_cbranch_scc1 L_k2_norm
    v_mov_b32 v16, v5
    v_mov_b32 v108, 0xff7fffff
    s_mov_b32 s24, 0
    s_nop 0
L_k2_maxloop:
    ds_read_b128 v[20:23], v16 offset:0
    s_waitcnt lgkmcnt(0)
    v_mfma_f32_32x32x16_bf16 v[36:51], v[20:23], v[8:11], 0
    s_nop 11
    v_max3_f32 v108, v108, v36, v37
    v_max3_f32 v108, v108, v38, v39
    v_max3_f32 v108, v108, v40, v41
    v_max3_f32 v108, v108, v42, v43
    v_max3_f32 v108, v108, v44, v45
    v_max3_f32 v108, v108, v46, v47
    v_max3_f32 v108, v108, v48, v49
    v_max3_f32 v108, v108, v50, v51
    v_add_u32 v16, 1024, v16
    s_add_u32 s24, s24, 1
    s_cmp_lt_u32 s24, 64
    s_cbranch_scc1 L_k2_maxloop
    v_mov_b32 v2, v108
    v_mov_b32 v3, v108
    s_nop 1
    v_permlane32_swap_b32 v2, v3
    v_max_f32 v108, v2, v3
    v_xor_b32 v92, 0x80000000, v108
    v_mov_b32 v93, v92
    v_mov_b32 v94, v92
    v_mov_b32 v95, v92
    v_mov_b32 v96, v92
    v_mov_b32 v97, v92
    v_mov_b32 v98, v92
    v_mov_b32 v99, v92
    v_mov_b32 v100, v92
    v_mov_b32 v101, v92
    v_mov_b32 v102, v92
    v_mov_b32 v103, v92
    v_mov_b32 v104, v92
    v_mov_b32 v105, v92
    v_mov_b32 v106, v92
    v_mov_b32 v107, v92
    v_mov_b32 v16, v5
    s_lshl_b32 s22, s20, 15
    v_mul_u32_u24 v2, 8, v18
    v_sub_u32 v17, v17, v2
    v_mov_b32 v76, 0
    v_mov_b32 v77, 0
    v_mov_b32 v78, 0
    v_mov_b32 v79, 0
    v_mov_b32 v80, 0
    v_mov_b32 v81, 0
    v_mov_b32 v82, 0
    v_mov_b32 v83, 0
    v_mov_b32 v84, 0
    v_mov_b32 v85, 0
    v_mov_b32 v86, 0
    v_mov_b32 v87, 0
    v_mov_b32 v88, 0
    v_mov_b32 v89, 0
    v_mov_b32 v90, 0
    v_mov_b32 v91, 0
    ds_read_b128 v[20:23], v16 offset:0
    ds_read_b128 v[24:27], v16 offset:1024
    s_waitcnt lgkmcnt(1)
    v_mfma_f32_32x32x16_bf16 v[36:51], v[20:23], v[8:11], v[92:107]
    s_mov_b32 s24, 0
    s_waitcnt lgkmcnt(0)
    s_nop 9
L_k2_loop2:
    ds_read_b128 v[20:23], v16 offset:2048
    ds_read_b64_tr_b16 v[28:29], v17 offset:0
    ds_read_b64_tr_b16 v[30:31], v17 offset:256
    ds_read_b64_tr_b16 v[32:33], v17 offset:512
    ds_read_b64_tr_b16 v[34:35], v17 offset:768
    v_mfma_f32_32x32x16_bf16 v[52:67], v[24:27], v[8:11], v[92:107]
    v_exp_f32 v36, v36
    v_exp_f32 v37, v37
    v_exp_f32 v38, v38
    v_exp_f32 v39, v39
    v_exp_f32 v40, v40
    v_exp_f32 v41, v41
    v_exp_f32 v42, v42
    v_exp_f32 v43, v43
    v_cvt_pk_bf16_f32 v68, v36, v37
    v_cvt_pk_bf16_f32 v69, v38, v39
    v_cvt_pk_bf16_f32 v70, v40, v41
    v_cvt_pk_bf16_f32 v71, v42, v43
    s_waitcnt lgkmcnt(2)
    s_nop 0
    v_mfma_f32_32x32x16_bf16 v[76:91], v[28:31], v[68:71], v[76:91]
    v_exp_f32 v44, v44
    v_exp_f32 v45, v45
    v_exp_f32 v46, v46
    v_exp_f32 v47, v47
    v_exp_f32 v48, v48
    v_exp_f32 v49, v49
    v_exp_f32 v50, v50
    v_exp_f32 v51, v51
    v_cvt_pk_bf16_f32 v72, v44, v45
    v_cvt_pk_bf16_f32 v73, v46, v47
    v_cvt_pk_bf16_f32 v74, v48, v49
    v_cvt_pk_bf16_f32 v75, v50, v51
    s_waitcnt lgkmcnt(0)
    s_nop 0
    v_mfma_f32_32x32x16_bf16 v[76:91], v[32:35], v[72:75], v[76:91]
    ds_read_b128 v[24:27], v16 offset:3072
    ds_read_b64_tr_b16 v[28:29], v17 offset:1024
    ds_read_b64_tr_b16 v[30:31], v17 offset:1280
    ds_read_b64_tr_b16 v[32:33], v17 offset:1536
    ds_read_b64_tr_b16 v[34:35], v17 offset:1792
    v_mfma_f32_32x32x16_bf16 v[36:51], v[20:23], v[8:11], v[92:107]
    v_exp_f32 v52, v52
    v_exp_f32 v53, v53
    v_exp_f32 v54, v54
    v_exp_f32 v55, v55
    v_exp_f32 v56, v56
    v_exp_f32 v57, v57
    v_exp_f32 v58, v58
    v_exp_f32 v59, v59
    v_cvt_pk_bf16_f32 v68, v52, v53
    v_cvt_pk_bf16_f32 v69, v54, v55
    v_cvt_pk_bf16_f32 v70, v56, v57
    v_cvt_pk_bf16_f32 v71, v58, v59
    s_waitcnt lgkmcnt(2)
    s_nop 0
    v_mfma_f32_32x32x16_bf16 v[76:91], v[28:31], v[68:71], v[76:91]
    v_exp_f32 v60, v60
    v_exp_f32 v61, v61
    v_exp_f32 v62, v62
    v_exp_f32 v63, v63
    v_exp_f32 v64, v64
    v_exp_f32 v65, v65
    v_exp_f32 v66, v66
    v_exp_f32 v67, v67
    v_cvt_pk_bf16_f32 v72, v60, v61
    v_cvt_pk_bf16_f32 v73, v62, v63
    v_cvt_pk_bf16_f32 v74, v64, v65
    v_cvt_pk_bf16_f32 v75, v66, v67
    s_waitcnt lgkmcnt(0)
    s_nop 0
    v_mfma_f32_32x32x16_bf16 v[76:91], v[32:35], v[72:75], v[76:91]
    ds_read_b128 v[20:23], v16 offset:4096
    ds_read_b64_tr_b16 v[28:29], v17 offset:2048
    ds_read_b64_tr_b16 v[30:31], v17 offset:2304
    ds_read_b64_tr_b16 v[32:33], v17 offset:2560
    ds_read_b64_tr_b16 v[34:35], v17 offset:2816
    v_mfma_f32_32x32x16_bf16 v[52:67], v[24:27], v[8:11], v[92:107]
    v_exp_f32 v36, v36
    v_exp_f32 v37, v37
    v_exp_f32 v38, v38
    v_exp_f32 v39, v39
    v_exp_f32 v40, v40
    v_exp_f32 v41, v41
    v_exp_f32 v42, v42
    v_exp_f32 v43, v43
    v_cvt_pk_bf16_f32 v68, v36, v37
    v_cvt_pk_bf16_f32 v69, v38, v39
    v_cvt_pk_bf16_f32 v70, v40, v41
    v_cvt_pk_bf16_f32 v71, v42, v43
    s_waitcnt lgkmcnt(2)
    s_nop 0
    v_mfma_f32_32x32x16_bf16 v[76:91], v[28:31], v[68:71], v[76:91]
    v_exp_f32 v44, v44
    v_exp_f32 v45, v45
    v_exp_f32 v46, v46
    v_exp_f32 v47, v47
    v_exp_f32 v48, v48
    v_exp_f32 v49, v49
    v_exp_f32 v50, v50
    v_exp_f32 v51, v51
    v_cvt_pk_bf16_f32 v72, v44, v45
    v_cvt_pk_bf16_f32 v73, v46, v47
    v_cvt_pk_bf16_f32 v74, v48, v49
    v_cvt_pk_bf16_f32 v75, v50, v51
    s_waitcnt lgkmcnt(0)
    s_nop 0
    v_mfma_f32_32x32x16_bf16 v[76:91], v[32:35], v[72:75], v[76:91]
    ds_read_b128 v[24:27], v16 offset:5120
    ds_read_b64_tr_b16 v[28:29], v17 offset:3072
    ds_read_b64_tr_b16 v[30:31], v17 offset:3328
    ds_read_b64_tr_b16 v[32:33], v17 offset:3584
    ds_read_b64_tr_b16 v[34:35], v17 offset:3840
    v_mfma_f32_32x32x16_bf16 v[36:51], v[20:23], v[8:11], v[92:107]
    v_exp_f32 v52, v52
    v_exp_f32 v53, v53
    v_exp_f32 v54, v54
    v_exp_f32 v55, v55
    v_exp_f32 v56, v56
    v_exp_f32 v57, v57
    v_exp_f32 v58, v58
    v_exp_f32 v59, v59
    v_cvt_pk_bf16_f32 v68, v52, v53
    v_cvt_pk_bf16_f32 v69, v54, v55
    v_cvt_pk_bf16_f32 v70, v56, v57
    v_cvt_pk_bf16_f32 v71, v58, v59
    s_waitcnt lgkmcnt(2)
    s_nop 0
    v_mfma_f32_32x32x16_bf16 v[76:91], v[28:31], v[68:71], v[76:91]
    v_exp_f32 v60, v60
    v_exp_f32 v61, v61
    v_exp_f32 v62, v62
    v_exp_f32 v63, v63
    v_exp_f32 v64, v64
    v_exp_f32 v65, v65
    v_exp_f32 v66, v66
    v_exp_f32 v67, v67
    v_cvt_pk_bf16_f32 v72, v60, v61
    v_cvt_pk_bf16_f32 v73, v62, v63
    v_cvt_pk_bf16_f32 v74, v64, v65
    v_cvt_pk_bf16_f32 v75, v66, v67
    s_waitcnt lgkmcnt(0)
    s_nop 0
    v_mfma_f32_32x32x16_bf16 v[76:91], v[32:35], v[72:75], v[76:91]
    v_add_u32 v16, 4096, v16
    v_add_u32 v17, v18, v17
    s_add_u32 s24, s24, 1
    s_cmp_lt_u32 s24, 16
    s_cbranch_scc1 L_k2_loop2
    s_nop 6
L_k2_norm:
    v_rcp_f32 v2, v84
    s_nop 0
    v_mul_f32 v76, v76, v2
    v_mul_f32 v77, v77, v2
    v_mul_f32 v78, v78, v2
    v_mul_f32 v79, v79, v2
    v_mul_f32 v80, v80, v2
    v_mul_f32 v81, v81, v2
    v_mul_f32 v82, v82, v2
    v_mul_f32 v83, v83, v2
    v_cvt_pk_bf16_f32 v68, v76, v77
    v_cvt_pk_bf16_f32 v69, v78, v79
    v_cvt_pk_bf16_f32 v70, v80, v81
    v_cvt_pk_bf16_f32 v71, v82, v83
    s_add_u32 s12, s4, 6291456
    s_addc_u32 s13, s5, 0
    s_and_b32 s13, s13, 0xffff
    s_mov_b32 s14, 2097152
    s_mov_b32 s15, 0x00020000
    s_lshl_b32 s21, s27, 5
    s_add_u32 s21, s21, s16
    s_lshl_b32 s21, s21, 10
    buffer_store_dwordx4 v[68:71], v12, s[12:15], s21 offen
    s_waitcnt vmcnt(0)
L_k2_end:
    s_endpgm
k2_attn_kernel_codeend:
.section .rodata,"a"
.p2align 6
.amdhsa_kernel k2_attn_kernel
  .amdhsa_next_free_vgpr 112
  .amdhsa_next_free_sgpr 56
  .amdhsa_accum_offset 112
  .amdhsa_group_segment_fixed_size 0
  .amdhsa_kernarg_size 80
  .amdhsa_user_sgpr_count 2
  .amdhsa_user_sgpr_kernarg_segment_ptr 1
  .amdhsa_system_sgpr_workgroup_id_x 1
.end_amdhsa_kernel
.text
.globl k3_oproj_kernel
.p2align 8
.type k3_oproj_kernel,@function
k3_oproj_kernel:

    s_cmp_ge_u32 s2, 256
    s_cbranch_scc1 L_k3_cs
    s_load_dwordx2 s[4:5], s[0:1], 72
    s_load_dwordx2 s[6:7], s[0:1], 16
    s_load_dwordx2 s[8:9], s[0:1], 0
    v_and_b32 v1, 63, v0
    v_lshrrev_b32 v2, 6, v0
    s_nop 0
    v_readfirstlane_b32 s30, v2
    s_and_b32 s31, s2, 7
    s_lshr_b32 s32, s2, 3
    s_lshl_b32 s28, s31, 2
    s_and_b32 s29, s32, 3
    s_add_u32 s28, s28, s29
    s_lshr_b32 s29, s32, 2
    v_lshlrev_b32 v5, 4, v1
    v_lshrrev_b32 v2, 3, v1
    v_lshlrev_b32 v6, 10, v2
    v_bfe_u32 v2, v1, 4, 1
    v_lshlrev_b32 v2, 2, v2
    v_and_b32 v3, 7, v1
    v_xor_b32 v2, v2, v3
    v_lshl_add_u32 v6, v2, 4, v6
    s_waitcnt lgkmcnt(0)
    s_add_u32 s12, s4, 6291456
    s_addc_u32 s13, s5, 0
    s_and_b32 s13, s13, 0xffff
    s_mov_b32 s14, 2097152
    s_mov_b32 s15, 0x00020000
    s_mov_b32 s16, s6
    s_mov_b32 s17, s7
    s_and_b32 s17, s17, 0xffff
    s_mov_b32 s18, 524288
    s_mov_b32 s19, 0x00020000
    s_mul_i32 s33, s28, 65536
    s_mul_i32 s31, s30, 8192
    s_add_u32 s33, s33, s31
    s_mul_i32 s34, s30, 131072
    s_lshl_b32 s31, s29, 7
    s_add_u32 s34, s34, s31
    s_mul_i32 s35, s30, 16384
    s_add_u32 s32, s33, 0
    buffer_load_dwordx4 v[8:11], v5, s[12:15], s32 offen
    s_add_u32 s32, s33, 32768
    buffer_load_dwordx4 v[12:15], v5, s[12:15], s32 offen
    s_add_u32 m0, s35, 0
    s_add_u32 s32, s34, 0
    buffer_load_dwordx4 v6, s[16:19], s32 offen lds
    s_add_u32 m0, s35, 1024
    s_add_u32 s32, s34, 8192
    buffer_load_dwordx4 v6, s[16:19], s32 offen lds
    s_add_u32 s32, s33, 1024
    buffer_load_dwordx4 v[16:19], v5, s[12:15], s32 offen
    s_add_u32 s32, s33, 33792
    buffer_load_dwordx4 v[20:23], v5, s[12:15], s32 offen
    s_add_u32 m0, s35, 2048
    s_add_u32 s32, s34, 16384
    buffer_load_dwordx4 v6, s[16:19], s32 offen lds
    s_add_u32 m0, s35, 3072
    s_add_u32 s32, s34, 24576
    buffer_load_dwordx4 v6, s[16:19], s32 offen lds
    s_add_u32 s32, s33, 2048
    buffer_load_dwordx4 v[24:27], v5, s[12:15], s32 offen
    s_add_u32 s32, s33, 34816
    buffer_load_dwordx4 v[28:31], v5, s[12:15], s32 offen
    s_add_u32 m0, s35, 4096
    s_add_u32 s32, s34, 32768
    buffer_load_dwordx4 v6, s[16:19], s32 offen lds
    s_add_u32 m0, s35, 5120
    s_add_u32 s32, s34, 40960
    buffer_load_dwordx4 v6, s[16:19], s32 offen lds
    s_add_u32 s32, s33, 3072
    buffer_load_dwordx4 v[32:35], v5, s[12:15], s32 offen
    s_add_u32 s32, s33, 35840
    buffer_load_dwordx4 v[36:39], v5, s[12:15], s32 offen
    s_add_u32 m0, s35, 6144
    s_add_u32 s32, s34, 49152
    buffer_load_dwordx4 v6, s[16:19], s32 offen lds
    s_add_u32 m0, s35, 7168
    s_add_u32 s32, s34, 57344
    buffer_load_dwordx4 v6, s[16:19], s32 offen lds
    s_add_u32 s32, s33, 4096
    buffer_load_dwordx4 v[40:43], v5, s[12:15], s32 offen
    s_add_u32 s32, s33, 36864
    buffer_load_dwordx4 v[44:47], v5, s[12:15], s32 offen
    s_add_u32 m0, s35, 8192
    s_add_u32 s32, s34, 65536
    buffer_load_dwordx4 v6, s[16:19], s32 offen lds
    s_add_u32 m0, s35, 9216
    s_add_u32 s32, s34, 73728
    buffer_load_dwordx4 v6, s[16:19], s32 offen lds
    s_add_u32 s32, s33, 5120
    buffer_load_dwordx4 v[48:51], v5, s[12:15], s32 offen
    s_add_u32 s32, s33, 37888
    buffer_load_dwordx4 v[52:55], v5, s[12:15], s32 offen
    s_add_u32 m0, s35, 10240
    s_add_u32 s32, s34, 81920
    buffer_load_dwordx4 v6, s[16:19], s32 offen lds
    s_add_u32 m0, s35, 11264
    s_add_u32 s32, s34, 90112
    buffer_load_dwordx4 v6, s[16:19], s32 offen lds
    s_add_u32 s32, s33, 6144
    buffer_load_dwordx4 v[56:59], v5, s[12:15], s32 offen
    s_add_u32 s32, s33, 38912
    buffer_load_dwordx4 v[60:63], v5, s[12:15], s32 offen
    s_add_u32 m0, s35, 12288
    s_add_u32 s32, s34, 98304
    buffer_load_dwordx4 v6, s[16:19], s32 offen lds
    s_add_u32 m0, s35, 13312
    s_add_u32 s32, s34, 106496
    buffer_load_dwordx4 v6, s[16:19], s32 offen lds
    s_add_u32 s32, s33, 7168
    buffer_load_dwordx4 v[64:67], v5, s[12:15], s32 offen
    s_add_u32 s32, s33, 39936
    buffer_load_dwordx4 v[68:71], v5, s[12:15], s32 offen
    s_add_u32 m0, s35, 14336
    s_add_u32 s32, s34, 114688
    buffer_load_dwordx4 v6, s[16:19], s32 offen lds
    s_add_u32 m0, s35, 15360
    s_add_u32 s32, s34, 122880
    buffer_load_dwordx4 v6, s[16:19], s32 offen lds
    s_lshr_b32 s31, s30, 1
    s_lshl_b32 s36, s28, 1
    s_add_u32 s36, s36, s31
    s_and_b32 s31, s30, 1
    s_lshl_b32 s37, s29, 1
    s_add_u32 s37, s37, s31
    s_add_u32 s20, s4, 8388608
    s_addc_u32 s21, s5, 0
    s_and_b32 s21, s21, 0xffff
    s_mov_b32 s22, 2097152
    s_mov_b32 s23, 0x00020000
    v_and_b32 v2, 31, v1
    v_lshlrev_b32 v88, 10, v2
    v_lshrrev_b32 v2, 5, v1
    v_lshl_add_u32 v88, v2, 3, v88
    s_lshl_b32 s31, s36, 15
    s_lshl_b32 s32, s37, 6
    s_add_u32 s38, s31, s32
    s_lshl_b32 s31, s36, 5
    s_lshl_b32 s32, s37, 1
    s_add_u32 s39, s31, s32
    s_lshl_b32 s39, s39, 10
    s_mov_b32 s24, s8
    s_mov_b32 s25, s9
    s_and_b32 s25, s25, 0xffff
    s_mov_b32 s26, 2097152
    s_mov_b32 s27, 0x00020000
    buffer_load_dwordx2 v[72:73], v88, s[24:27], s38 offen offset:0
    buffer_load_dwordx2 v[74:75], v88, s[24:27], s38 offen offset:16
    buffer_load_dwordx2 v[76:77], v88, s[24:27], s38 offen offset:32
    buffer_load_dwordx2 v[78:79], v88, s[24:27], s38 offen offset:48
    v_lshrrev_b32 v2, 5, v1
    v_lshlrev_b32 v2, 3, v2
    v_bfe_u32 v3, v1, 2, 2
    v_add_u32 v2, v2, v3
    v_lshlrev_b32 v89, 7, v2
    v_bfe_u32 v2, v1, 4, 1
    v_lshlrev_b32 v2, 1, v2
    v_bfe_u32 v3, v1, 1, 1
    v_add_u32 v2, v2, v3
    v_bfe_u32 v3, v1, 3, 1
    v_lshlrev_b32 v3, 2, v3
    v_xor_b32 v2, v2, v3
    v_lshl_add_u32 v89, v2, 4, v89
    v_and_b32 v2, 1, v1
    v_lshl_add_u32 v89, v2, 3, v89
    v_add_u32 v89, s35, v89
    v_xor_b32 v90, 64, v89
    s_waitcnt vmcnt(32)
    ds_read_b64_tr_b16 v[92:93], v89 offset:0
    ds_read_b64_tr_b16 v[94:95], v89 offset:512
    ds_read_b64_tr_b16 v[96:97], v90 offset:0
    ds_read_b64_tr_b16 v[98:99], v90 offset:512
    s_waitcnt vmcnt(28)
    ds_read_b64_tr_b16 v[100:101], v89 offset:2048
    ds_read_b64_tr_b16 v[102:103], v89 offset:2560
    ds_read_b64_tr_b16 v[104:105], v90 offset:2048
    ds_read_b64_tr_b16 v[106:107], v90 offset:2560
    s_waitcnt lgkmcnt(6)
    v_mfma_f32_32x32x16_bf16 v[108:123], v[92:95], v[8:11], 0
    s_waitcnt lgkmcnt(4)
    v_mfma_f32_32x32x16_bf16 v[124:139], v[96:99], v[8:11], 0
    v_mfma_f32_32x32x16_bf16 v[140:155], v[92:95], v[12:15], 0
    v_mfma_f32_32x32x16_bf16 v[156:171], v[96:99], v[12:15], 0
    s_waitcnt vmcnt(24)
    ds_read_b64_tr_b16 v[92:93], v89 offset:4096
    ds_read_b64_tr_b16 v[94:95], v89 offset:4608
    ds_read_b64_tr_b16 v[96:97], v90 offset:4096
    ds_read_b64_tr_b16 v[98:99], v90 offset:4608
    s_waitcnt lgkmcnt(6)
    v_mfma_f32_32x32x16_bf16 v[108:123], v[100:103], v[16:19], v[108:123]
    s_waitcnt lgkmcnt(4)
    v_mfma_f32_32x32x16_bf16 v[124:139], v[104:107], v[16:19], v[124:139]
    v_mfma_f32_32x32x16_bf16 v[140:155], v[100:103], v[20:23], v[140:155]
    v_mfma_f32_32x32x16_bf16 v[156:171], v[104:107], v[20:23], v[156:171]
    s_waitcnt vmcnt(20)
    ds_read_b64_tr_b16 v[100:101], v89 offset:6144
    ds_read_b64_tr_b16 v[102:103], v89 offset:6656
    ds_read_b64_tr_b16 v[104:105], v90 offset:6144
    ds_read_b64_tr_b16 v[106:107], v90 offset:6656
    s_waitcnt lgkmcnt(6)
    v_mfma_f32_32x32x16_bf16 v[108:123], v[92:95], v[24:27], v[108:123]
    s_waitcnt lgkmcnt(4)
    v_mfma_f32_32x32x16_bf16 v[124:139], v[96:99], v[24:27], v[124:139]
    v_mfma_f32_32x32x16_bf16 v[140:155], v[92:95], v[28:31], v[140:155]
    v_mfma_f32_32x32x16_bf16 v[156:171], v[96:99], v[28:31], v[156:171]
    s_waitcnt vmcnt(16)
    ds_read_b64_tr_b16 v[92:93], v89 offset:8192
    ds_read_b64_tr_b16 v[94:95], v89 offset:8704
    ds_read_b64_tr_b16 v[96:97], v90 offset:8192
    ds_read_b64_tr_b16 v[98:99], v90 offset:8704
    s_waitcnt lgkmcnt(6)
    v_mfma_f32_32x32x16_bf16 v[108:123], v[100:103], v[32:35], v[108:123]
    s_waitcnt lgkmcnt(4)
    v_mfma_f32_32x32x16_bf16 v[124:139], v[104:107], v[32:35], v[124:139]
    v_mfma_f32_32x32x16_bf16 v[140:155], v[100:103], v[36:39], v[140:155]
    v_mfma_f32_32x32x16_bf16 v[156:171], v[104:107], v[36:39], v[156:171]
    s_waitcnt vmcnt(12)
    ds_read_b64_tr_b16 v[100:101], v89 offset:10240
    ds_read_b64_tr_b16 v[102:103], v89 offset:10752
    ds_read_b64_tr_b16 v[104:105], v90 offset:10240
    ds_read_b64_tr_b16 v[106:107], v90 offset:10752
    s_waitcnt lgkmcnt(6)
    v_mfma_f32_32x32x16_bf16 v[108:123], v[92:95], v[40:43], v[108:123]
    s_waitcnt lgkmcnt(4)
    v_mfma_f32_32x32x16_bf16 v[124:139], v[96:99], v[40:43], v[124:139]
    v_mfma_f32_32x32x16_bf16 v[140:155], v[92:95], v[44:47], v[140:155]
    v_mfma_f32_32x32x16_bf16 v[156:171], v[96:99], v[44:47], v[156:171]
    s_waitcnt vmcnt(8)
    ds_read_b64_tr_b16 v[92:93], v89 offset:12288
    ds_read_b64_tr_b16 v[94:95], v89 offset:12800
    ds_read_b64_tr_b16 v[96:97], v90 offset:12288
    ds_read_b64_tr_b16 v[98:99], v90 offset:12800
    s_waitcnt lgkmcnt(6)
    v_mfma_f32_32x32x16_bf16 v[108:123], v[100:103], v[48:51], v[108:123]
    s_waitcnt lgkmcnt(4)
    v_mfma_f32_32x32x16_bf16 v[124:139], v[104:107], v[48:51], v[124:139]
    v_mfma_f32_32x32x16_bf16 v[140:155], v[100:103], v[52:55], v[140:155]
    v_mfma_f32_32x32x16_bf16 v[156:171], v[104:107], v[52:55], v[156:171]
    s_waitcnt vmcnt(4)
    ds_read_b64_tr_b16 v[100:101], v89 offset:14336
    ds_read_b64_tr_b16 v[102:103], v89 offset:14848
    ds_read_b64_tr_b16 v[104:105], v90 offset:14336
    ds_read_b64_tr_b16 v[106:107], v90 offset:14848
    s_waitcnt lgkmcnt(6)
    v_mfma_f32_32x32x16_bf16 v[108:123], v[92:95], v[56:59], v[108:123]
    s_waitcnt lgkmcnt(4)
    v_mfma_f32_32x32x16_bf16 v[124:139], v[96:99], v[56:59], v[124:139]
    v_mfma_f32_32x32x16_bf16 v[140:155], v[92:95], v[60:63], v[140:155]
    v_mfma_f32_32x32x16_bf16 v[156:171], v[96:99], v[60:63], v[156:171]
    s_waitcnt lgkmcnt(2)
    v_mfma_f32_32x32x16_bf16 v[108:123], v[100:103], v[64:67], v[108:123]
    s_waitcnt lgkmcnt(0)
    v_mfma_f32_32x32x16_bf16 v[124:139], v[104:107], v[64:67], v[124:139]
    v_mfma_f32_32x32x16_bf16 v[140:155], v[100:103], v[68:71], v[140:155]
    v_mfma_f32_32x32x16_bf16 v[156:171], v[104:107], v[68:71], v[156:171]
    v_add_u32 v172, s35, v5
    s_nop 6
    ds_write_b128 v172, v[108:111] offset:0
    ds_write_b128 v172, v[112:115] offset:1024
    ds_write_b128 v172, v[116:119] offset:2048
    ds_write_b128 v172, v[120:123] offset:3072
    ds_write_b128 v172, v[124:127] offset:4096
    ds_write_b128 v172, v[128:131] offset:5120
    ds_write_b128 v172, v[132:135] offset:6144
    ds_write_b128 v172, v[136:139] offset:7168
    ds_write_b128 v172, v[140:143] offset:8192
    ds_write_b128 v172, v[144:147] offset:9216
    ds_write_b128 v172, v[148:151] offset:10240
    ds_write_b128 v172, v[152:155] offset:11264
    ds_write_b128 v172, v[156:159] offset:12288
    ds_write_b128 v172, v[160:163] offset:13312
    ds_write_b128 v172, v[164:167] offset:14336
    ds_write_b128 v172, v[168:171] offset:15360
    s_waitcnt lgkmcnt(0)
    s_barrier
    s_lshl_b32 s31, s30, 12
    v_add_u32 v172, s31, v5
    v_add_u32 v173, 32768, v172
    ds_read_b128 v[108:111], v172 offset:0
    ds_read_b128 v[112:115], v172 offset:1024
    ds_read_b128 v[116:119], v172 offset:2048
    ds_read_b128 v[120:123], v172 offset:3072
    ds_read_b128 v[8:11], v172 offset:16384
    ds_read_b128 v[12:15], v172 offset:17408
    ds_read_b128 v[16:19], v172 offset:18432
    ds_read_b128 v[20:23], v172 offset:19456
    s_waitcnt lgkmcnt(3)
    v_add_f32 v108, v108, v8
    v_add_f32 v109, v109, v9
    v_add_f32 v110, v110, v10
    v_add_f32 v111, v111, v11
    s_waitcnt lgkmcnt(2)
    v_add_f32 v112, v112, v12
    v_add_f32 v113, v113, v13
    v_add_f32 v114, v114, v14
    v_add_f32 v115, v115, v15
    s_waitcnt lgkmcnt(1)
    v_add_f32 v116, v116, v16
    v_add_f32 v117, v117, v17
    v_add_f32 v118, v118, v18
    v_add_f32 v119, v119, v19
    s_waitcnt lgkmcnt(0)
    v_add_f32 v120, v120, v20
    v_add_f32 v121, v121, v21
    v_add_f32 v122, v122, v22
    v_add_f32 v123, v123, v23
    ds_read_b128 v[8:11], v173 offset:0
    ds_read_b128 v[12:15], v173 offset:1024
    ds_read_b128 v[16:19], v173 offset:2048
    ds_read_b128 v[20:23], v173 offset:3072
    s_waitcnt lgkmcnt(3)
    v_add_f32 v108, v108, v8
    v_add_f32 v109, v109, v9
    v_add_f32 v110, v110, v10
    v_add_f32 v111, v111, v11
    s_waitcnt lgkmcnt(2)
    v_add_f32 v112, v112, v12
    v_add_f32 v113, v113, v13
    v_add_f32 v114, v114, v14
    v_add_f32 v115, v115, v15
    s_waitcnt lgkmcnt(1)
    v_add_f32 v116, v116, v16
    v_add_f32 v117, v117, v17
    v_add_f32 v118, v118, v18
    v_add_f32 v119, v119, v19
    s_waitcnt lgkmcnt(0)
    v_add_f32 v120, v120, v20
    v_add_f32 v121, v121, v21
    v_add_f32 v122, v122, v22
    v_add_f32 v123, v123, v23
    ds_read_b128 v[8:11], v173 offset:16384
    ds_read_b128 v[12:15], v173 offset:17408
    ds_read_b128 v[16:19], v173 offset:18432
    ds_read_b128 v[20:23], v173 offset:19456
    s_waitcnt lgkmcnt(3)
    v_add_f32 v108, v108, v8
    v_add_f32 v109, v109, v9
    v_add_f32 v110, v110, v10
    v_add_f32 v111, v111, v11
    s_waitcnt lgkmcnt(2)
    v_add_f32 v112, v112, v12
    v_add_f32 v113, v113, v13
    v_add_f32 v114, v114, v14
    v_add_f32 v115, v115, v15
    s_waitcnt lgkmcnt(1)
    v_add_f32 v116, v116, v16
    v_add_f32 v117, v117, v17
    v_add_f32 v118, v118, v18
    v_add_f32 v119, v119, v19
    s_waitcnt lgkmcnt(0)
    v_add_f32 v120, v120, v20
    v_add_f32 v121, v121, v21
    v_add_f32 v122, v122, v22
    v_add_f32 v123, v123, v23
    v_cvt_pk_bf16_f32 v80, v108, v109
    v_cvt_pk_bf16_f32 v81, v110, v111
    v_cvt_pk_bf16_f32 v82, v112, v113
    v_cvt_pk_bf16_f32 v83, v114, v115
    v_cvt_pk_bf16_f32 v84, v116, v117
    v_cvt_pk_bf16_f32 v85, v118, v119
    v_cvt_pk_bf16_f32 v86, v120, v121
    v_cvt_pk_bf16_f32 v87, v122, v123
    v_lshlrev_b32 v2, 16, v80
    s_waitcnt vmcnt(3)
    v_lshlrev_b32 v3, 16, v72
    v_add_f32 v108, v2, v3
    v_and_b32 v2, 0xffff0000, v80
    v_and_b32 v3, 0xffff0000, v72
    v_add_f32 v109, v2, v3
    v_lshlrev_b32 v2, 16, v81
    v_lshlrev_b32 v3, 16, v73
    v_add_f32 v110, v2, v3
    v_and_b32 v2, 0xffff0000, v81
    v_and_b32 v3, 0xffff0000, v73
    v_add_f32 v111, v2, v3
    v_lshlrev_b32 v2, 16, v82
    s_waitcnt vmcnt(2)
    v_lshlrev_b32 v3, 16, v74
    v_add_f32 v112, v2, v3
    v_and_b32 v2, 0xffff0000, v82
    v_and_b32 v3, 0xffff0000, v74
    v_add_f32 v113, v2, v3
    v_lshlrev_b32 v2, 16, v83
    v_lshlrev_b32 v3, 16, v75
    v_add_f32 v114, v2, v3
    v_and_b32 v2, 0xffff0000, v83
    v_and_b32 v3, 0xffff0000, v75
    v_add_f32 v115, v2, v3
    v_lshlrev_b32 v2, 16, v84
    s_waitcnt vmcnt(1)
    v_lshlrev_b32 v3, 16, v76
    v_add_f32 v116, v2, v3
    v_and_b32 v2, 0xffff0000, v84
    v_and_b32 v3, 0xffff0000, v76
    v_add_f32 v117, v2, v3
    v_lshlrev_b32 v2, 16, v85
    v_lshlrev_b32 v3, 16, v77
    v_add_f32 v118, v2, v3
    v_and_b32 v2, 0xffff0000, v85
    v_and_b32 v3, 0xffff0000, v77
    v_add_f32 v119, v2, v3
    v_lshlrev_b32 v2, 16, v86
    s_waitcnt vmcnt(0)
    v_lshlrev_b32 v3, 16, v78
    v_add_f32 v120, v2, v3
    v_and_b32 v2, 0xffff0000, v86
    v_and_b32 v3, 0xffff0000, v78
    v_add_f32 v121, v2, v3
    v_lshlrev_b32 v2, 16, v87
    v_lshlrev_b32 v3, 16, v79
    v_add_f32 v122, v2, v3
    v_and_b32 v2, 0xffff0000, v87
    v_and_b32 v3, 0xffff0000, v79
    v_add_f32 v123, v2, v3
    v_cvt_pk_bf16_f32 v80, v108, v109
    v_cvt_pk_bf16_f32 v81, v110, v111
    v_cvt_pk_bf16_f32 v82, v112, v113
    v_cvt_pk_bf16_f32 v83, v114, v115
    v_cvt_pk_bf16_f32 v84, v116, v117
    v_cvt_pk_bf16_f32 v85, v118, v119
    v_cvt_pk_bf16_f32 v86, v120, v121
    v_cvt_pk_bf16_f32 v87, v122, v123
    buffer_store_dwordx4 v[80:83], v5, s[20:23], s39 offen offset:0
    buffer_store_dwordx4 v[84:87], v5, s[20:23], s39 offen offset:1024
    v_lshlrev_b32 v108, 16, v80
    v_and_b32 v109, 0xffff0000, v80
    v_lshlrev_b32 v110, 16, v81
    v_and_b32 v111, 0xffff0000, v81
    v_lshlrev_b32 v112, 16, v82
    v_and_b32 v113, 0xffff0000, v82
    v_lshlrev_b32 v114, 16, v83
    v_and_b32 v115, 0xffff0000, v83
    v_lshlrev_b32 v116, 16, v84
    v_and_b32 v117, 0xffff0000, v84
    v_lshlrev_b32 v118, 16, v85
    v_and_b32 v119, 0xffff0000, v85
    v_lshlrev_b32 v120, 16, v86
    v_and_b32 v121, 0xffff0000, v86
    v_lshlrev_b32 v122, 16, v87
    v_and_b32 v123, 0xffff0000, v87
    v_add_f32 v72, v108, v109
    v_add_f32 v72, v72, v110
    v_add_f32 v72, v72, v111
    v_add_f32 v72, v72, v112
    v_add_f32 v72, v72, v113
    v_add_f32 v72, v72, v114
    v_add_f32 v72, v72, v115
    v_add_f32 v72, v72, v116
    v_add_f32 v72, v72, v117
    v_add_f32 v72, v72, v118
    v_add_f32 v72, v72, v119
    v_add_f32 v72, v72, v120
    v_add_f32 v72, v72, v121
    v_add_f32 v72, v72, v122
    v_add_f32 v72, v72, v123
    v_mov_b32 v2, v72
    v_mov_b32 v3, v72
    s_nop 1
    v_permlane32_swap_b32 v2, v3
    v_add_f32 v72, v2, v3
    v_mul_f32 v4, 0x3d000000, v72
    v_mov_b32 v73, 0
    v_sub_f32 v108, v108, v4
    v_fmac_f32 v73, v108, v108
    v_sub_f32 v109, v109, v4
    v_fmac_f32 v73, v109, v109
    v_sub_f32 v110, v110, v4
    v_fmac_f32 v73, v110, v110
    v_sub_f32 v111, v111, v4
    v_fmac_f32 v73, v111, v111
    v_sub_f32 v112, v112, v4
    v_fmac_f32 v73, v112, v112
    v_sub_f32 v113, v113, v4
    v_fmac_f32 v73, v113, v113
    v_sub_f32 v114, v114, v4
    v_fmac_f32 v73, v114, v114
    v_sub_f32 v115, v115, v4
    v_fmac_f32 v73, v115, v115
    v_sub_f32 v116, v116, v4
    v_fmac_f32 v73, v116, v116
    v_sub_f32 v117, v117, v4
    v_fmac_f32 v73, v117, v117
    v_sub_f32 v118, v118, v4
    v_fmac_f32 v73, v118, v118
    v_sub_f32 v119, v119, v4
    v_fmac_f32 v73, v119, v119
    v_sub_f32 v120, v120, v4
    v_fmac_f32 v73, v120, v120
    v_sub_f32 v121, v121, v4
    v_fmac_f32 v73, v121, v121
    v_sub_f32 v122, v122, v4
    v_fmac_f32 v73, v122, v122
    v_sub_f32 v123, v123, v4
    v_fmac_f32 v73, v123, v123
    v_mov_b32 v2, v73
    v_mov_b32 v3, v73
    s_nop 1
    v_permlane32_swap_b32 v2, v3
    v_add_f32 v73, v2, v3
    s_add_u32 s12, s4, 17825792
    s_addc_u32 s13, s5, 0
    s_and_b32 s13, s13, 0xffff
    s_mov_b32 s14, 262144
    s_mov_b32 s15, 0x00020000
    v_and_b32 v2, 31, v1
    v_lshlrev_b32 v2, 7, v2
    s_lshl_b32 s31, s36, 12
    s_lshl_b32 s32, s37, 3
    s_add_u32 s31, s31, s32
    buffer_store_dwordx2 v[72:73], v2, s[12:15], s31 offen
    s_waitcnt vmcnt(0)
    s_endpgm
L_k3_cs:
    s_cmp_ge_u32 s2, 312
    s_cbranch_scc1 L_k3_end
    s_load_dwordx2 s[4:5], s[0:1], 32
    s_load_dwordx2 s[6:7], s[0:1], 40
    s_load_dwordx2 s[8:9], s[0:1], 72
    v_and_b32 v1, 63, v0
    v_lshrrev_b32 v2, 6, v0
    s_nop 0
    v_readfirstlane_b32 s26, v2
    s_sub_u32 s24, s2, 256
    s_cmp_ge_u32 s24, 28
    s_cselect_b32 s25, 28, 0
    s_sub_u32 s27, s24, s25
    v_lshrrev_b32 v3, 4, v1
    v_mul_u32_u24 v3, 3584, v3
    v_and_b32 v4, 15, v1
    v_lshl_add_u32 v3, v4, 3, v3
    s_mul_i32 s28, s26, 458752
    s_lshl_b32 s29, s27, 7
    s_add_u32 s28, s28, s29
    s_waitcnt lgkmcnt(0)
    s_cmp_ge_u32 s24, 28
    s_cselect_b32 s4, s6, s4
    s_cselect_b32 s5, s7, s5
    s_mov_b32 s12, s4
    s_mov_b32 s13, s5
    s_and_b32 s13, s13, 0xffff
    s_mov_b32 s14, 1835008
    s_mov_b32 s15, 0x00020000
    buffer_load_dwordx2 v[16:17], v3, s[12:15], s28 offen
    s_add_u32 s28, s28, 14336
    buffer_load_dwordx2 v[18:19], v3, s[12:15], s28 offen
    s_add_u32 s28, s28, 14336
    buffer_load_dwordx2 v[20:21], v3, s[12:15], s28 offen
    s_add_u32 s28, s28, 14336
    buffer_load_dwordx2 v[22:23], v3, s[12:15], s28 offen
    s_add_u32 s28, s28, 14336
    buffer_load_dwordx2 v[24:25], v3, s[12:15], s28 offen
    s_add_u32 s28, s28, 14336
    buffer_load_dwordx2 v[26:27], v3, s[12:15], s28 offen
    s_add_u32 s28, s28, 14336
    buffer_load_dwordx2 v[28:29], v3, s[12:15], s28 offen
    s_add_u32 s28, s28, 14336
    buffer_load_dwordx2 v[30:31], v3, s[12:15], s28 offen
    s_add_u32 s28, s28, 14336
    buffer_load_dwordx2 v[32:33], v3, s[12:15], s28 offen
    s_add_u32 s28, s28, 14336
    buffer_load_dwordx2 v[34:35], v3, s[12:15], s28 offen
    s_add_u32 s28, s28, 14336
    buffer_load_dwordx2 v[36:37], v3, s[12:15], s28 offen
    s_add_u32 s28, s28, 14336
    buffer_load_dwordx2 v[38:39], v3, s[12:15], s28 offen
    s_add_u32 s28, s28, 14336
    buffer_load_dwordx2 v[40:41], v3, s[12:15], s28 offen
    s_add_u32 s28, s28, 14336
    buffer_load_dwordx2 v[42:43], v3, s[12:15], s28 offen
    s_add_u32 s28, s28, 14336
    buffer_load_dwordx2 v[44:45], v3, s[12:15], s28 offen
    s_add_u32 s28, s28, 14336
    buffer_load_dwordx2 v[46:47], v3, s[12:15], s28 offen
    s_add_u32 s28, s28, 14336
    buffer_load_dwordx2 v[48:49], v3, s[12:15], s28 offen
    s_add_u32 s28, s28, 14336
    buffer_load_dwordx2 v[50:51], v3, s[12:15], s28 offen
    s_add_u32 s28, s28, 14336
    buffer_load_dwordx2 v[52:53], v3, s[12:15], s28 offen
    s_add_u32 s28, s28, 14336
    buffer_load_dwordx2 v[54:55], v3, s[12:15], s28 offen
    s_add_u32 s28, s28, 14336
    buffer_load_dwordx2 v[56:57], v3, s[12:15], s28 offen
    s_add_u32 s28, s28, 14336
    buffer_load_dwordx2 v[58:59], v3, s[12:15], s28 offen
    s_add_u32 s28, s28, 14336
    buffer_load_dwordx2 v[60:61], v3, s[12:15], s28 offen
    s_add_u32 s28, s28, 14336
    buffer_load_dwordx2 v[62:63], v3, s[12:15], s28 offen
    s_add_u32 s28, s28, 14336
    buffer_load_dwordx2 v[64:65], v3, s[12:15], s28 offen
    s_add_u32 s28, s28, 14336
    buffer_load_dwordx2 v[66:67], v3, s[12:15], s28 offen
    s_add_u32 s28, s28, 14336
    buffer_load_dwordx2 v[68:69], v3, s[12:15], s28 offen
    s_add_u32 s28, s28, 14336
    buffer_load_dwordx2 v[70:71], v3, s[12:15], s28 offen
    s_add_u32 s28, s28, 14336
    buffer_load_dwordx2 v[72:73], v3, s[12:15], s28 offen
    s_add_u32 s28, s28, 14336
    buffer_load_dwordx2 v[74:75], v3, s[12:15], s28 offen
    s_add_u32 s28, s28, 14336
    buffer_load_dwordx2 v[76:77], v3, s[12:15], s28 offen
    s_add_u32 s28, s28, 14336
    buffer_load_dwordx2 v[78:79], v3, s[12:15], s28 offen
    s_add_u32 s28, s28, 14336
    s_add_u32 s16, s8, 18087936
    s_addc_u32 s17, s9, 0
    s_and_b32 s17, s17, 0xffff
    s_mov_b32 s18, 14336
    s_mov_b32 s19, 0x00020000
    v_mov_b32 v8, 0
    v_mov_b32 v9, 0
    v_mov_b32 v10, 0
    v_mov_b32 v11, 0
    s_waitcnt vmcnt(31)
    v_lshlrev_b32 v5, 16, v16
    v_add_f32 v8, v8, v5
    v_and_b32 v6, 0xffff0000, v16
    v_add_f32 v9, v9, v6
    v_lshlrev_b32 v5, 16, v17
    v_add_f32 v10, v10, v5
    v_and_b32 v6, 0xffff0000, v17
    v_add_f32 v11, v11, v6
    s_waitcnt vmcnt(30)
    v_lshlrev_b32 v5, 16, v18
    v_add_f32 v8, v8, v5
    v_and_b32 v6, 0xffff0000, v18
    v_add_f32 v9, v9, v6
    v_lshlrev_b32 v5, 16, v19
    v_add_f32 v10, v10, v5
    v_and_b32 v6, 0xffff0000, v19
    v_add_f32 v11, v11, v6
    s_waitcnt vmcnt(29)
    v_lshlrev_b32 v5, 16, v20
    v_add_f32 v8, v8, v5
    v_and_b32 v6, 0xffff0000, v20
    v_add_f32 v9, v9, v6
    v_lshlrev_b32 v5, 16, v21
    v_add_f32 v10, v10, v5
    v_and_b32 v6, 0xffff0000, v21
    v_add_f32 v11, v11, v6
    s_waitcnt vmcnt(28)
    v_lshlrev_b32 v5, 16, v22
    v_add_f32 v8, v8, v5
    v_and_b32 v6, 0xffff0000, v22
    v_add_f32 v9, v9, v6
    v_lshlrev_b32 v5, 16, v23
    v_add_f32 v10, v10, v5
    v_and_b32 v6, 0xffff0000, v23
    v_add_f32 v11, v11, v6
    s_waitcnt vmcnt(27)
    v_lshlrev_b32 v5, 16, v24
    v_add_f32 v8, v8, v5
    v_and_b32 v6, 0xffff0000, v24
    v_add_f32 v9, v9, v6
    v_lshlrev_b32 v5, 16, v25
    v_add_f32 v10, v10, v5
    v_and_b32 v6, 0xffff0000, v25
    v_add_f32 v11, v11, v6
    s_waitcnt vmcnt(26)
    v_lshlrev_b32 v5, 16, v26
    v_add_f32 v8, v8, v5
    v_and_b32 v6, 0xffff0000, v26
    v_add_f32 v9, v9, v6
    v_lshlrev_b32 v5, 16, v27
    v_add_f32 v10, v10, v5
    v_and_b32 v6, 0xffff0000, v27
    v_add_f32 v11, v11, v6
    s_waitcnt vmcnt(25)
    v_lshlrev_b32 v5, 16, v28
    v_add_f32 v8, v8, v5
    v_and_b32 v6, 0xffff0000, v28
    v_add_f32 v9, v9, v6
    v_lshlrev_b32 v5, 16, v29
    v_add_f32 v10, v10, v5
    v_and_b32 v6, 0xffff0000, v29
    v_add_f32 v11, v11, v6
    s_waitcnt vmcnt(24)
    v_lshlrev_b32 v5, 16, v30
    v_add_f32 v8, v8, v5
    v_and_b32 v6, 0xffff0000, v30
    v_add_f32 v9, v9, v6
    v_lshlrev_b32 v5, 16, v31
    v_add_f32 v10, v10, v5
    v_and_b32 v6, 0xffff0000, v31
    v_add_f32 v11, v11, v6
    s_waitcnt vmcnt(23)
    v_lshlrev_b32 v5, 16, v32
    v_add_f32 v8, v8, v5
    v_and_b32 v6, 0xffff0000, v32
    v_add_f32 v9, v9, v6
    v_lshlrev_b32 v5, 16, v33
    v_add_f32 v10, v10, v5
    v_and_b32 v6, 0xffff0000, v33
    v_add_f32 v11, v11, v6
    s_waitcnt vmcnt(22)
    v_lshlrev_b32 v5, 16, v34
    v_add_f32 v8, v8, v5
    v_and_b32 v6, 0xffff0000, v34
    v_add_f32 v9, v9, v6
    v_lshlrev_b32 v5, 16, v35
    v_add_f32 v10, v10, v5
    v_and_b32 v6, 0xffff0000, v35
    v_add_f32 v11, v11, v6
    s_waitcnt vmcnt(21)
    v_lshlrev_b32 v5, 16, v36
    v_add_f32 v8, v8, v5
    v_and_b32 v6, 0xffff0000, v36
    v_add_f32 v9, v9, v6
    v_lshlrev_b32 v5, 16, v37
    v_add_f32 v10, v10, v5
    v_and_b32 v6, 0xffff0000, v37
    v_add_f32 v11, v11, v6
    s_waitcnt vmcnt(20)
    v_lshlrev_b32 v5, 16, v38
    v_add_f32 v8, v8, v5
    v_and_b32 v6, 0xffff0000, v38
    v_add_f32 v9, v9, v6
    v_lshlrev_b32 v5, 16, v39
    v_add_f32 v10, v10, v5
    v_and_b32 v6, 0xffff0000, v39
    v_add_f32 v11, v11, v6
    s_waitcnt vmcnt(19)
    v_lshlrev_b32 v5, 16, v40
    v_add_f32 v8, v8, v5
    v_and_b32 v6, 0xffff0000, v40
    v_add_f32 v9, v9, v6
    v_lshlrev_b32 v5, 16, v41
    v_add_f32 v10, v10, v5
    v_and_b32 v6, 0xffff0000, v41
    v_add_f32 v11, v11, v6
    s_waitcnt vmcnt(18)
    v_lshlrev_b32 v5, 16, v42
    v_add_f32 v8, v8, v5
    v_and_b32 v6, 0xffff0000, v42
    v_add_f32 v9, v9, v6
    v_lshlrev_b32 v5, 16, v43
    v_add_f32 v10, v10, v5
    v_and_b32 v6, 0xffff0000, v43
    v_add_f32 v11, v11, v6
    s_waitcnt vmcnt(17)
    v_lshlrev_b32 v5, 16, v44
    v_add_f32 v8, v8, v5
    v_and_b32 v6, 0xffff0000, v44
    v_add_f32 v9, v9, v6
    v_lshlrev_b32 v5, 16, v45
    v_add_f32 v10, v10, v5
    v_and_b32 v6, 0xffff0000, v45
    v_add_f32 v11, v11, v6
    s_waitcnt vmcnt(16)
    v_lshlrev_b32 v5, 16, v46
    v_add_f32 v8, v8, v5
    v_and_b32 v6, 0xffff0000, v46
    v_add_f32 v9, v9, v6
    v_lshlrev_b32 v5, 16, v47
    v_add_f32 v10, v10, v5
    v_and_b32 v6, 0xffff0000, v47
    v_add_f32 v11, v11, v6
    s_waitcnt vmcnt(15)
    v_lshlrev_b32 v5, 16, v48
    v_add_f32 v8, v8, v5
    v_and_b32 v6, 0xffff0000, v48
    v_add_f32 v9, v9, v6
    v_lshlrev_b32 v5, 16, v49
    v_add_f32 v10, v10, v5
    v_and_b32 v6, 0xffff0000, v49
    v_add_f32 v11, v11, v6
    s_waitcnt vmcnt(14)
    v_lshlrev_b32 v5, 16, v50
    v_add_f32 v8, v8, v5
    v_and_b32 v6, 0xffff0000, v50
    v_add_f32 v9, v9, v6
    v_lshlrev_b32 v5, 16, v51
    v_add_f32 v10, v10, v5
    v_and_b32 v6, 0xffff0000, v51
    v_add_f32 v11, v11, v6
    s_waitcnt vmcnt(13)
    v_lshlrev_b32 v5, 16, v52
    v_add_f32 v8, v8, v5
    v_and_b32 v6, 0xffff0000, v52
    v_add_f32 v9, v9, v6
    v_lshlrev_b32 v5, 16, v53
    v_add_f32 v10, v10, v5
    v_and_b32 v6, 0xffff0000, v53
    v_add_f32 v11, v11, v6
    s_waitcnt vmcnt(12)
    v_lshlrev_b32 v5, 16, v54
    v_add_f32 v8, v8, v5
    v_and_b32 v6, 0xffff0000, v54
    v_add_f32 v9, v9, v6
    v_lshlrev_b32 v5, 16, v55
    v_add_f32 v10, v10, v5
    v_and_b32 v6, 0xffff0000, v55
    v_add_f32 v11, v11, v6
    s_waitcnt vmcnt(11)
    v_lshlrev_b32 v5, 16, v56
    v_add_f32 v8, v8, v5
    v_and_b32 v6, 0xffff0000, v56
    v_add_f32 v9, v9, v6
    v_lshlrev_b32 v5, 16, v57
    v_add_f32 v10, v10, v5
    v_and_b32 v6, 0xffff0000, v57
    v_add_f32 v11, v11, v6
    s_waitcnt vmcnt(10)
    v_lshlrev_b32 v5, 16, v58
    v_add_f32 v8, v8, v5
    v_and_b32 v6, 0xffff0000, v58
    v_add_f32 v9, v9, v6
    v_lshlrev_b32 v5, 16, v59
    v_add_f32 v10, v10, v5
    v_and_b32 v6, 0xffff0000, v59
    v_add_f32 v11, v11, v6
    s_waitcnt vmcnt(9)
    v_lshlrev_b32 v5, 16, v60
    v_add_f32 v8, v8, v5
    v_and_b32 v6, 0xffff0000, v60
    v_add_f32 v9, v9, v6
    v_lshlrev_b32 v5, 16, v61
    v_add_f32 v10, v10, v5
    v_and_b32 v6, 0xffff0000, v61
    v_add_f32 v11, v11, v6
    s_waitcnt vmcnt(8)
    v_lshlrev_b32 v5, 16, v62
    v_add_f32 v8, v8, v5
    v_and_b32 v6, 0xffff0000, v62
    v_add_f32 v9, v9, v6
    v_lshlrev_b32 v5, 16, v63
    v_add_f32 v10, v10, v5
    v_and_b32 v6, 0xffff0000, v63
    v_add_f32 v11, v11, v6
    s_waitcnt vmcnt(7)
    v_lshlrev_b32 v5, 16, v64
    v_add_f32 v8, v8, v5
    v_and_b32 v6, 0xffff0000, v64
    v_add_f32 v9, v9, v6
    v_lshlrev_b32 v5, 16, v65
    v_add_f32 v10, v10, v5
    v_and_b32 v6, 0xffff0000, v65
    v_add_f32 v11, v11, v6
    s_waitcnt vmcnt(6)
    v_lshlrev_b32 v5, 16, v66
    v_add_f32 v8, v8, v5
    v_and_b32 v6, 0xffff0000, v66
    v_add_f32 v9, v9, v6
    v_lshlrev_b32 v5, 16, v67
    v_add_f32 v10, v10, v5
    v_and_b32 v6, 0xffff0000, v67
    v_add_f32 v11, v11, v6
    s_waitcnt vmcnt(5)
    v_lshlrev_b32 v5, 16, v68
    v_add_f32 v8, v8, v5
    v_and_b32 v6, 0xffff0000, v68
    v_add_f32 v9, v9, v6
    v_lshlrev_b32 v5, 16, v69
    v_add_f32 v10, v10, v5
    v_and_b32 v6, 0xffff0000, v69
    v_add_f32 v11, v11, v6
    s_waitcnt vmcnt(4)
    v_lshlrev_b32 v5, 16, v70
    v_add_f32 v8, v8, v5
    v_and_b32 v6, 0xffff0000, v70
    v_add_f32 v9, v9, v6
    v_lshlrev_b32 v5, 16, v71
    v_add_f32 v10, v10, v5
    v_and_b32 v6, 0xffff0000, v71
    v_add_f32 v11, v11, v6
    s_waitcnt vmcnt(3)
    v_lshlrev_b32 v5, 16, v72
    v_add_f32 v8, v8, v5
    v_and_b32 v6, 0xffff0000, v72
    v_add_f32 v9, v9, v6
    v_lshlrev_b32 v5, 16, v73
    v_add_f32 v10, v10, v5
    v_and_b32 v6, 0xffff0000, v73
    v_add_f32 v11, v11, v6
    s_waitcnt vmcnt(2)
    v_lshlrev_b32 v5, 16, v74
    v_add_f32 v8, v8, v5
    v_and_b32 v6, 0xffff0000, v74
    v_add_f32 v9, v9, v6
    v_lshlrev_b32 v5, 16, v75
    v_add_f32 v10, v10, v5
    v_and_b32 v6, 0xffff0000, v75
    v_add_f32 v11, v11, v6
    s_waitcnt vmcnt(1)
    v_lshlrev_b32 v5, 16, v76
    v_add_f32 v8, v8, v5
    v_and_b32 v6, 0xffff0000, v76
    v_add_f32 v9, v9, v6
    v_lshlrev_b32 v5, 16, v77
    v_add_f32 v10, v10, v5
    v_and_b32 v6, 0xffff0000, v77
    v_add_f32 v11, v11, v6
    s_waitcnt vmcnt(0)
    v_lshlrev_b32 v5, 16, v78
    v_add_f32 v8, v8, v5
    v_and_b32 v6, 0xffff0000, v78
    v_add_f32 v9, v9, v6
    v_lshlrev_b32 v5, 16, v79
    v_add_f32 v10, v10, v5
    v_and_b32 v6, 0xffff0000, v79
    v_add_f32 v11, v11, v6
    v_mov_b32 v5, v8
    v_mov_b32 v6, v8
    s_nop 1
    v_permlane32_swap_b32 v5, v6
    v_add_f32 v8, v5, v6
    v_mov_b32 v5, v8
    v_mov_b32 v6, v8
    s_nop 1
    v_permlane16_swap_b32 v5, v6
    v_add_f32 v8, v5, v6
    v_mov_b32 v5, v9
    v_mov_b32 v6, v9
    s_nop 1
    v_permlane32_swap_b32 v5, v6
    v_add_f32 v9, v5, v6
    v_mov_b32 v5, v9
    v_mov_b32 v6, v9
    s_nop 1
    v_permlane16_swap_b32 v5, v6
    v_add_f32 v9, v5, v6
    v_mov_b32 v5, v10
    v_mov_b32 v6, v10
    s_nop 1
    v_permlane32_swap_b32 v5, v6
    v_add_f32 v10, v5, v6
    v_mov_b32 v5, v10
    v_mov_b32 v6, v10
    s_nop 1
    v_permlane16_swap_b32 v5, v6
    v_add_f32 v10, v5, v6
    v_mov_b32 v5, v11
    v_mov_b32 v6, v11
    s_nop 1
    v_permlane32_swap_b32 v5, v6
    v_add_f32 v11, v5, v6
    v_mov_b32 v5, v11
    v_mov_b32 v6, v11
    s_nop 1
    v_permlane16_swap_b32 v5, v6
    v_add_f32 v11, v5, v6
    v_lshlrev_b32 v5, 4, v4
    s_lshl_b32 s29, s26, 8
    v_add_u32 v5, s29, v5
    ds_write_b128 v5, v[8:11]
    s_waitcnt lgkmcnt(0)
    s_barrier
    v_lshlrev_b32 v5, 4, v4
    ds_read_b128 v[16:19], v5 offset:0
    ds_read_b128 v[20:23], v5 offset:256
    ds_read_b128 v[24:27], v5 offset:512
    ds_read_b128 v[28:31], v5 offset:768
    s_waitcnt lgkmcnt(2)
    v_add_f32 v16, v16, v20
    s_waitcnt lgkmcnt(0)
    v_add_f32 v24, v24, v28
    v_add_f32 v16, v16, v24
    v_add_f32 v17, v17, v21
    v_add_f32 v25, v25, v29
    v_add_f32 v17, v17, v25
    v_add_f32 v18, v18, v22
    v_add_f32 v26, v26, v30
    v_add_f32 v18, v18, v26
    v_add_f32 v19, v19, v23
    v_add_f32 v27, v27, v31
    v_add_f32 v19, v19, v27
    s_lshl_b32 s29, s24, 8
    buffer_store_dwordx4 v[16:19], v5, s[16:19], s29 offen
    s_waitcnt vmcnt(0)
L_k3_end:
    s_endpgm
k3_oproj_kernel_codeend:
.section .rodata,"a"
.p2align 6
.amdhsa_kernel k3_oproj_kernel
  .amdhsa_next_free_vgpr 176
  .amdhsa_next_free_sgpr 56
  .amdhsa_accum_offset 176
  .amdhsa_group_segment_fixed_size 0
  .amdhsa_kernarg_size 80
  .amdhsa_user_sgpr_count 2
  .amdhsa_user_sgpr_kernarg_segment_ptr 1
  .amdhsa_system_sgpr_workgroup_id_x 1
.end_amdhsa_kernel
.text
.globl k4_ffn1_kernel
.p2align 8
.type k4_ffn1_kernel,@function
k4_ffn1_kernel:

    s_cmp_ge_u32 s2, 256
    s_cbranch_scc1 L_k4_end
    s_load_dwordx2 s[4:5], s[0:1], 72
    s_load_dwordx2 s[6:7], s[0:1], 32
    s_load_dwordx2 s[8:9], s[0:1], 40
    s_load_dwordx2 s[40:41], s[0:1], 48
    v_and_b32 v1, 63, v0
    v_lshrrev_b32 v2, 6, v0
    s_nop 0
    v_readfirstlane_b32 s26, v2
    s_and_b32 s27, s2, 7
    s_lshr_b32 s28, s2, 3
    s_and_b32 s24, s27, 3
    s_lshl_b32 s24, s24, 2
    s_and_b32 s25, s28, 3
    s_add_u32 s24, s24, s25
    s_lshr_b32 s25, s27, 2
    s_lshl_b32 s25, s25, 3
    s_lshr_b32 s28, s28, 2
    s_add_u32 s25, s25, s28
    v_lshlrev_b32 v4, 4, v1
    s_lshl_b32 s31, s24, 2
    s_add_u32 s31, s31, s26
    v_add_u32 v2, 0, v1
    v_mul_u32_u24 v3, 2341, v2
    v_lshrrev_b32 v3, 15, v3
    v_mul_u32_u24 v5, 14, v3
    v_sub_u32 v2, v2, v5
    v_mul_u32_u24 v5, 3584, v3
    v_lshl_add_u32 v5, v2, 4, v5
    v_add_u32 v2, 64, v1
    v_mul_u32_u24 v3, 2341, v2
    v_lshrrev_b32 v3, 15, v3
    v_mul_u32_u24 v6, 14, v3
    v_sub_u32 v2, v2, v6
    v_mul_u32_u24 v6, 3584, v3
    v_lshl_add_u32 v6, v2, 4, v6
    v_add_u32 v2, 128, v1
    v_mul_u32_u24 v3, 2341, v2
    v_lshrrev_b32 v3, 15, v3
    v_mul_u32_u24 v7, 14, v3
    v_sub_u32 v2, v2, v7
    v_mul_u32_u24 v7, 3584, v3
    v_lshl_add_u32 v7, v2, 4, v7
    v_add_u32 v2, 192, v1
    v_mul_u32_u24 v3, 2341, v2
    v_lshrrev_b32 v3, 15, v3
    v_mul_u32_u24 v8, 14, v3
    v_sub_u32 v2, v2, v8
    v_mul_u32_u24 v8, 3584, v3
    v_lshl_add_u32 v8, v2, 4, v8
    v_add_u32 v2, 256, v1
    v_mul_u32_u24 v3, 2341, v2
    v_lshrrev_b32 v3, 15, v3
    v_mul_u32_u24 v9, 14, v3
    v_sub_u32 v2, v2, v9
    v_mul_u32_u24 v9, 3584, v3
    v_lshl_add_u32 v9, v2, 4, v9
    v_add_u32 v2, 320, v1
    v_mul_u32_u24 v3, 2341, v2
    v_lshrrev_b32 v3, 15, v3
    v_mul_u32_u24 v10, 14, v3
    v_sub_u32 v2, v2, v10
    v_mul_u32_u24 v10, 3584, v3
    v_lshl_add_u32 v10, v2, 4, v10
    v_add_u32 v2, 384, v1
    v_mul_u32_u24 v3, 2341, v2
    v_lshrrev_b32 v3, 15, v3
    v_mul_u32_u24 v11, 14, v3
    v_sub_u32 v2, v2, v11
    v_mul_u32_u24 v11, 3584, v3
    v_lshl_add_u32 v11, v2, 4, v11
    s_lshr_b32 s27, s26, 1
    s_and_b32 s28, s26, 1
    s_mul_i32 s29, s25, 224
    s_mul_i32 s30, s28, 114688
    s_add_u32 s29, s29, s30
    s_mul_i32 s39, s27, 14464
    s_mul_i32 s28, s28, 7168
    s_add_u32 s39, s39, s28
    s_mov_b32 s30, s39
    s_lshl_b32 s36, s31, 15
    s_waitcnt lgkmcnt(0)
    s_cmp_eq_u32 s27, 0
    s_cselect_b32 s6, s6, s8
    s_cselect_b32 s7, s7, s9
    s_mov_b32 s16, s6
    s_mov_b32 s17, s7
    s_and_b32 s17, s17, 0xffff
    s_mov_b32 s18, 1835008
    s_mov_b32 s19, 0x00020000
    s_add_u32 s12, s4, 8388608
    s_addc_u32 s13, s5, 0
    s_and_b32 s13, s13, 0xffff
    s_mov_b32 s14, 2097152
    s_mov_b32 s15, 0x00020000
    s_add_u32 s20, s4, 18087936
    s_addc_u32 s21, s5, 0
    s_and_b32 s21, s21, 0xffff
    s_mov_b32 s22, 14336
    s_mov_b32 s23, 0x00020000
    v_lshlrev_b32 v3, 2, v1
    s_lshr_b32 s27, s26, 1
    s_and_b32 s28, s26, 1
    s_lshl_b32 s37, s27, 9
    s_lshl_b32 s38, s28, 8
    s_add_u32 s37, s37, s38
    s_add_u32 m0, s37, 144640
    s_mul_i32 s27, s27, 7168
    s_add_u32 s27, s27, s38
    s_mul_i32 s28, s25, 448
    s_add_u32 s27, s27, s28
    buffer_load_dword v3, s[20:23], s27 offen lds
    v_lshrrev_b32 v2, 5, v1
    s_add_u32 s32, s4, 17825792
    s_addc_u32 s33, s5, 0
    s_and_b32 s33, s33, 0xffff
    s_mov_b32 s34, 262144
    s_mov_b32 s35, 0x00020000
    v_and_b32 v3, 31, v1
    v_lshlrev_b32 v3, 7, v3
    v_lshl_add_u32 v3, v2, 6, v3
    s_lshl_b32 s27, s31, 12
    buffer_load_dwordx4 v[44:47], v3, s[32:35], s27 offen offset:0
    buffer_load_dwordx4 v[48:51], v3, s[32:35], s27 offen offset:16
    buffer_load_dwordx4 v[52:55], v3, s[32:35], s27 offen offset:32
    buffer_load_dwordx4 v[56:59], v3, s[32:35], s27 offen offset:48
    s_add_u32 m0, s30, 0
    s_nop 0
    buffer_load_dwordx4 v5, s[16:19], s29 offen lds
    s_add_u32 m0, s30, 1024
    s_nop 0
    buffer_load_dwordx4 v6, s[16:19], s29 offen lds
    s_add_u32 m0, s30, 2048
    s_nop 0
    buffer_load_dwordx4 v7, s[16:19], s29 offen lds
    s_add_u32 m0, s30, 3072
    s_nop 0
    buffer_load_dwordx4 v8, s[16:19], s29 offen lds
    s_add_u32 m0, s30, 4096
    s_nop 0
    buffer_load_dwordx4 v9, s[16:19], s29 offen lds
    s_add_u32 m0, s30, 5120
    s_nop 0
    buffer_load_dwordx4 v10, s[16:19], s29 offen lds
    s_add_u32 m0, s30, 6144
    s_nop 0
    buffer_load_dwordx4 v11, s[16:19], s29 offen lds
    s_add_u32 s29, s29, 229376
    s_add_u32 s30, s30, 28928
    s_sub_u32 s28, s30, s39
    s_cmp_ge_u32 s28, 144640
    s_cselect_b32 s30, s39, s30
    s_add_u32 m0, s30, 0
    s_nop 0
    buffer_load_dwordx4 v5, s[16:19], s29 offen lds
    s_add_u32 m0, s30, 1024
    s_nop 0
    buffer_load_dwordx4 v6, s[16:19], s29 offen lds
    buffer_load_dwordx4 v[12:15], v4, s[12:15], s36 offen offset:0
    s_add_u32 m0, s30, 2048
    s_nop 0
    buffer_load_dwordx4 v7, s[16:19], s29 offen lds
    s_add_u32 m0, s30, 3072
    s_nop 0
    buffer_load_dwordx4 v8, s[16:19], s29 offen lds
    buffer_load_dwordx4 v[16:19], v4, s[12:15], s36 offen offset:1024
    s_add_u32 m0, s30, 4096
    s_nop 0
    buffer_load_dwordx4 v9, s[16:19], s29 offen lds
    buffer_load_dwordx4 v[20:23], v4, s[12:15], s36 offen offset:2048
    s_add_u32 m0, s30, 5120
    s_nop 0
    buffer_load_dwordx4 v10, s[16:19], s29 offen lds
    s_add_u32 m0, s30, 6144
    s_nop 0
    buffer_load_dwordx4 v11, s[16:19], s29 offen lds
    buffer_load_dwordx4 v[24:27], v4, s[12:15], s36 offen offset:3072
    s_add_u32 s36, s36, 4096
    s_add_u32 s29, s29, 229376
    s_add_u32 s30, s30, 28928
    s_sub_u32 s28, s30, s39
    s_cmp_ge_u32 s28, 144640
    s_cselect_b32 s30, s39, s30
    s_add_u32 m0, s30, 0
    s_nop 0
    buffer_load_dwordx4 v5, s[16:19], s29 offen lds
    s_add_u32 m0, s30, 1024
    s_nop 0
    buffer_load_dwordx4 v6, s[16:19], s29 offen lds
    buffer_load_dwordx4 v[28:31], v4, s[12:15], s36 offen offset:0
    s_add_u32 m0, s30, 2048
    s_nop 0
    buffer_load_dwordx4 v7, s[16:19], s29 offen lds
    s_add_u32 m0, s30, 3072
    s_nop 0
    buffer_load_dwordx4 v8, s[16:19], s29 offen lds
    buffer_load_dwordx4 v[32:35], v4, s[12:15], s36 offen offset:1024
    s_add_u32 m0, s30, 4096
    s_nop 0
    buffer_load_dwordx4 v9, s[16:19], s29 offen lds
    buffer_load_dwordx4 v[36:39], v4, s[12:15], s36 offen offset:2048
    s_add_u32 m0, s30, 5120
    s_nop 0
    buffer_load_dwordx4 v10, s[16:19], s29 offen lds
    s_add_u32 m0, s30, 6144
    s_nop 0
    buffer_load_dwordx4 v11, s[16:19], s29 offen lds
    buffer_load_dwordx4 v[40:43], v4, s[12:15], s36 offen offset:3072
    s_add_u32 s36, s36, 4096
    s_add_u32 s29, s29, 229376
    s_add_u32 s30, s30, 28928
    s_sub_u32 s28, s30, s39
    s_cmp_ge_u32 s28, 144640
    s_cselect_b32 s30, s39, s30
    v_lshrrev_b32 v2, 5, v1
    v_lshlrev_b32 v2, 2, v2
    v_bfe_u32 v3, v1, 2, 2
    v_add_u32 v2, v2, v3
    v_mul_u32_u24 v60, 224, v2
    v_bfe_u32 v2, v1, 4, 1
    v_mul_u32_u24 v2, 14464, v2
    v_add_u32 v60, v60, v2
    v_and_b32 v2, 3, v1
    v_lshl_add_u32 v60, v2, 3, v60
    s_sub_u32 s38, 0, 28928
    v_accvgpr_write_b32 a0, 0
    v_accvgpr_write_b32 a1, 0
    v_accvgpr_write_b32 a2, 0
    v_accvgpr_write_b32 a3, 0
    v_accvgpr_write_b32 a4, 0
    v_accvgpr_write_b32 a5, 0
    v_accvgpr_write_b32 a6, 0
    v_accvgpr_write_b32 a7, 0
    v_accvgpr_write_b32 a8, 0
    v_accvgpr_write_b32 a9, 0
    v_accvgpr_write_b32 a10, 0
    v_accvgpr_write_b32 a11, 0
    v_accvgpr_write_b32 a12, 0
    v_accvgpr_write_b32 a13, 0
    v_accvgpr_write_b32 a14, 0
    v_accvgpr_write_b32 a15, 0
    v_accvgpr_write_b32 a16, 0
    v_accvgpr_write_b32 a17, 0
    v_accvgpr_write_b32 a18, 0
    v_accvgpr_write_b32 a19, 0
    v_accvgpr_write_b32 a20, 0
    v_accvgpr_write_b32 a21, 0
    v_accvgpr_write_b32 a22, 0
    v_accvgpr_write_b32 a23, 0
    v_accvgpr_write_b32 a24, 0
    v_accvgpr_write_b32 a25, 0
    v_accvgpr_write_b32 a26, 0
    v_accvgpr_write_b32 a27, 0
    v_accvgpr_write_b32 a28, 0
    v_accvgpr_write_b32 a29, 0
    v_accvgpr_write_b32 a30, 0
    v_accvgpr_write_b32 a31, 0
    v_accvgpr_write_b32 a32, 0
    v_accvgpr_write_b32 a33, 0
    v_accvgpr_write_b32 a34, 0
    v_accvgpr_write_b32 a35, 0
    v_accvgpr_write_b32 a36, 0
    v_accvgpr_write_b32 a37, 0
    v_accvgpr_write_b32 a38, 0
    v_accvgpr_write_b32 a39, 0
    v_accvgpr_write_b32 a40, 0
    v_accvgpr_write_b32 a41, 0
    v_accvgpr_write_b32 a42, 0
    v_accvgpr_write_b32 a43, 0
    v_accvgpr_write_b32 a44, 0
    v_accvgpr_write_b32 a45, 0
    v_accvgpr_write_b32 a46, 0
    v_accvgpr_write_b32 a47, 0
    v_accvgpr_write_b32 a48, 0
    v_accvgpr_write_b32 a49, 0
    v_accvgpr_write_b32 a50, 0
    v_accvgpr_write_b32 a51, 0
    v_accvgpr_write_b32 a52, 0
    v_accvgpr_write_b32 a53, 0
    v_accvgpr_write_b32 a54, 0
    v_accvgpr_write_b32 a55, 0
    v_accvgpr_write_b32 a56, 0
    v_accvgpr_write_b32 a57, 0
    v_accvgpr_write_b32 a58, 0
    v_accvgpr_write_b32 a59, 0
    v_accvgpr_write_b32 a60, 0
    v_accvgpr_write_b32 a61, 0
    v_accvgpr_write_b32 a62, 0
    v_accvgpr_write_b32 a63, 0
    v_accvgpr_write_b32 a64, 0
    v_accvgpr_write_b32 a65, 0
    v_accvgpr_write_b32 a66, 0
    v_accvgpr_write_b32 a67, 0
    v_accvgpr_write_b32 a68, 0
    v_accvgpr_write_b32 a69, 0
    v_accvgpr_write_b32 a70, 0
    v_accvgpr_write_b32 a71, 0
    v_accvgpr_write_b32 a72, 0
    v_accvgpr_write_b32 a73, 0
    v_accvgpr_write_b32 a74, 0
    v_accvgpr_write_b32 a75, 0
    v_accvgpr_write_b32 a76, 0
    v_accvgpr_write_b32 a77, 0
    v_accvgpr_write_b32 a78, 0
    v_accvgpr_write_b32 a79, 0
    v_accvgpr_write_b32 a80, 0
    v_accvgpr_write_b32 a81, 0
    v_accvgpr_write_b32 a82, 0
    v_accvgpr_write_b32 a83, 0
    v_accvgpr_write_b32 a84, 0
    v_accvgpr_write_b32 a85, 0
    v_accvgpr_write_b32 a86, 0
    v_accvgpr_write_b32 a87, 0
    v_accvgpr_write_b32 a88, 0
    v_accvgpr_write_b32 a89, 0
    v_accvgpr_write_b32 a90, 0
    v_accvgpr_write_b32 a91, 0
    v_accvgpr_write_b32 a92, 0
    v_accvgpr_write_b32 a93, 0
    v_accvgpr_write_b32 a94, 0
    v_accvgpr_write_b32 a95, 0
    v_accvgpr_write_b32 a96, 0
    v_accvgpr_write_b32 a97, 0
    v_accvgpr_write_b32 a98, 0
    v_accvgpr_write_b32 a99, 0
    v_accvgpr_write_b32 a100, 0
    v_accvgpr_write_b32 a101, 0
    v_accvgpr_write_b32 a102, 0
    v_accvgpr_write_b32 a103, 0
    v_accvgpr_write_b32 a104, 0
    v_accvgpr_write_b32 a105, 0
    v_accvgpr_write_b32 a106, 0
    v_accvgpr_write_b32 a107, 0
    v_accvgpr_write_b32 a108, 0
    v_accvgpr_write_b32 a109, 0
    v_accvgpr_write_b32 a110, 0
    v_accvgpr_write_b32 a111, 0
    s_waitcnt vmcnt(22)
    s_barrier
    s_add_u32 s38, s38, 28928
    s_cmp_ge_u32 s38, 144640
    s_cselect_b32 s38, 0, s38
    v_add_u32 v61, s38, v60
    ds_read_b64_tr_b16 v[64:65], v61 offset:0
    ds_read_b64_tr_b16 v[66:67], v61 offset:1792
    ds_read_b64_tr_b16 v[68:69], v61 offset:32
    ds_read_b64_tr_b16 v[70:71], v61 offset:1824
    ds_read_b64_tr_b16 v[72:73], v61 offset:64
    ds_read_b64_tr_b16 v[74:75], v61 offset:1856
    ds_read_b64_tr_b16 v[76:77], v61 offset:96
    ds_read_b64_tr_b16 v[78:79], v61 offset:1888
    s_mov_b32 s37, 0
    s_waitcnt lgkmcnt(0)
L_k4_loop:
    ds_read_b64_tr_b16 v[80:81], v61 offset:128
    ds_read_b64_tr_b16 v[82:83], v61 offset:1920
    s_waitcnt vmcnt(19)
    v_mfma_f32_32x32x16_bf16 a[0:15], v[64:67], v[12:15], a[0:15]
    ds_read_b64_tr_b16 v[84:85], v61 offset:160
    ds_read_b64_tr_b16 v[86:87], v61 offset:1952
    v_mfma_f32_32x32x16_bf16 a[16:31], v[68:71], v[12:15], a[16:31]
    s_add_u32 m0, s30, 0
    s_nop 0
    buffer_load_dwordx4 v5, s[16:19], s29 offen lds
    ds_read_b64_tr_b16 v[88:89], v61 offset:192
    ds_read_b64_tr_b16 v[90:91], v61 offset:1984
    v_mfma_f32_32x32x16_bf16 a[32:47], v[72:75], v[12:15], a[32:47]
    ds_read_b64_tr_b16 v[64:65], v61 offset:3584
    ds_read_b64_tr_b16 v[66:67], v61 offset:5376
    v_mfma_f32_32x32x16_bf16 a[48:63], v[76:79], v[12:15], a[48:63]
    ds_read_b64_tr_b16 v[68:69], v61 offset:3616
    ds_read_b64_tr_b16 v[70:71], v61 offset:5408
    s_waitcnt lgkmcnt(8)
    v_mfma_f32_32x32x16_bf16 a[64:79], v[80:83], v[12:15], a[64:79]
    ds_read_b64_tr_b16 v[72:73], v61 offset:3648
    ds_read_b64_tr_b16 v[74:75], v61 offset:5440
    s_waitcnt lgkmcnt(8)
    v_mfma_f32_32x32x16_bf16 a[80:95], v[84:87], v[12:15], a[80:95]
    s_add_u32 m0, s30, 1024
    s_nop 0
    buffer_load_dwordx4 v6, s[16:19], s29 offen lds
    ds_read_b64_tr_b16 v[76:77], v61 offset:3680
    ds_read_b64_tr_b16 v[78:79], v61 offset:5472
    s_waitcnt lgkmcnt(8)
    v_mfma_f32_32x32x16_bf16 a[96:111], v[88:91], v[12:15], a[96:111]
    buffer_load_dwordx4 v[12:15], v4, s[12:15], s36 offen offset:0
    ds_read_b64_tr_b16 v[80:81], v61 offset:3712
    ds_read_b64_tr_b16 v[82:83], v61 offset:5504
    s_waitcnt vmcnt(19) lgkmcnt(8)
    v_mfma_f32_32x32x16_bf16 a[0:15], v[64:67], v[16:19], a[0:15]
    ds_read_b64_tr_b16 v[84:85], v61 offset:3744
    ds_read_b64_tr_b16 v[86:87], v61 offset:5536
    s_waitcnt lgkmcnt(8)
    v_mfma_f32_32x32x16_bf16 a[16:31], v[68:71], v[16:19], a[16:31]
    ds_read_b64_tr_b16 v[88:89], v61 offset:3776
    ds_read_b64_tr_b16 v[90:91], v61 offset:5568
    s_waitcnt lgkmcnt(8)
    v_mfma_f32_32x32x16_bf16 a[32:47], v[72:75], v[16:19], a[32:47]
    s_add_u32 m0, s30, 2048
    s_nop 0
    buffer_load_dwordx4 v7, s[16:19], s29 offen lds
    ds_read_b64_tr_b16 v[64:65], v61 offset:7168
    ds_read_b64_tr_b16 v[66:67], v61 offset:8960
    s_waitcnt lgkmcnt(8)
    v_mfma_f32_32x32x16_bf16 a[48:63], v[76:79], v[16:19], a[48:63]
    ds_read_b64_tr_b16 v[68:69], v61 offset:7200
    ds_read_b64_tr_b16 v[70:71], v61 offset:8992
    s_waitcnt lgkmcnt(8)
    v_mfma_f32_32x32x16_bf16 a[64:79], v[80:83], v[16:19], a[64:79]
    ds_read_b64_tr_b16 v[72:73], v61 offset:7232
    ds_read_b64_tr_b16 v[74:75], v61 offset:9024
    s_waitcnt lgkmcnt(8)
    v_mfma_f32_32x32x16_bf16 a[80:95], v[84:87], v[16:19], a[80:95]
    ds_read_b64_tr_b16 v[76:77], v61 offset:7264
    ds_read_b64_tr_b16 v[78:79], v61 offset:9056
    s_waitcnt lgkmcnt(8)
    v_mfma_f32_32x32x16_bf16 a[96:111], v[88:91], v[16:19], a[96:111]
    s_add_u32 m0, s30, 3072
    s_nop 0
    buffer_load_dwordx4 v8, s[16:19], s29 offen lds
    buffer_load_dwordx4 v[16:19], v4, s[12:15], s36 offen offset:1024
    ds_read_b64_tr_b16 v[80:81], v61 offset:7296
    ds_read_b64_tr_b16 v[82:83], v61 offset:9088
    s_waitcnt vmcnt(20) lgkmcnt(8)
    v_mfma_f32_32x32x16_bf16 a[0:15], v[64:67], v[20:23], a[0:15]
    ds_read_b64_tr_b16 v[84:85], v61 offset:7328
    ds_read_b64_tr_b16 v[86:87], v61 offset:9120
    s_waitcnt lgkmcnt(8)
    v_mfma_f32_32x32x16_bf16 a[16:31], v[68:71], v[20:23], a[16:31]
    ds_read_b64_tr_b16 v[88:89], v61 offset:7360
    ds_read_b64_tr_b16 v[90:91], v61 offset:9152
    s_waitcnt lgkmcnt(8)
    v_mfma_f32_32x32x16_bf16 a[32:47], v[72:75], v[20:23], a[32:47]
    ds_read_b64_tr_b16 v[64:65], v61 offset:10752
    ds_read_b64_tr_b16 v[66:67], v61 offset:12544
    s_waitcnt lgkmcnt(8)
    v_mfma_f32_32x32x16_bf16 a[48:63], v[76:79], v[20:23], a[48:63]
    s_add_u32 m0, s30, 4096
    s_nop 0
    buffer_load_dwordx4 v9, s[16:19], s29 offen lds
    ds_read_b64_tr_b16 v[68:69], v61 offset:10784
    ds_read_b64_tr_b16 v[70:71], v61 offset:12576
    s_waitcnt lgkmcnt(8)
    v_mfma_f32_32x32x16_bf16 a[64:79], v[80:83], v[20:23], a[64:79]
    ds_read_b64_tr_b16 v[72:73], v61 offset:10816
    ds_read_b64_tr_b16 v[74:75], v61 offset:12608
    s_waitcnt lgkmcnt(8)
    v_mfma_f32_32x32x16_bf16 a[80:95], v[84:87], v[20:23], a[80:95]
    ds_read_b64_tr_b16 v[76:77], v61 offset:10848
    ds_read_b64_tr_b16 v[78:79], v61 offset:12640
    s_waitcnt lgkmcnt(8)
    v_mfma_f32_32x32x16_bf16 a[96:111], v[88:91], v[20:23], a[96:111]
    buffer_load_dwordx4 v[20:23], v4, s[12:15], s36 offen offset:2048
    ds_read_b64_tr_b16 v[80:81], v61 offset:10880
    ds_read_b64_tr_b16 v[82:83], v61 offset:12672
    s_waitcnt vmcnt(19) lgkmcnt(8)
    v_mfma_f32_32x32x16_bf16 a[0:15], v[64:67], v[24:27], a[0:15]
    s_add_u32 m0, s30, 5120
    s_nop 0
    buffer_load_dwordx4 v10, s[16:19], s29 offen lds
    ds_read_b64_tr_b16 v[84:85], v61 offset:10912
    ds_read_b64_tr_b16 v[86:87], v61 offset:12704
    s_waitcnt lgkmcnt(8)
    v_mfma_f32_32x32x16_bf16 a[16:31], v[68:71], v[24:27], a[16:31]
    ds_read_b64_tr_b16 v[88:89], v61 offset:10944
    ds_read_b64_tr_b16 v[90:91], v61 offset:12736
    s_waitcnt lgkmcnt(8)
    v_mfma_f32_32x32x16_bf16 a[32:47], v[72:75], v[24:27], a[32:47]
    s_waitcnt lgkmcnt(0)
    s_barrier
    s_add_u32 s38, s38, 28928
    s_cmp_ge_u32 s38, 144640
    s_cselect_b32 s38, 0, s38
    v_add_u32 v62, s38, v60
    ds_read_b64_tr_b16 v[64:65], v62 offset:0
    ds_read_b64_tr_b16 v[66:67], v62 offset:1792
    v_mfma_f32_32x32x16_bf16 a[48:63], v[76:79], v[24:27], a[48:63]
    ds_read_b64_tr_b16 v[68:69], v62 offset:32
    ds_read_b64_tr_b16 v[70:71], v62 offset:1824
    v_mfma_f32_32x32x16_bf16 a[64:79], v[80:83], v[24:27], a[64:79]
    s_add_u32 m0, s30, 6144
    s_nop 0
    buffer_load_dwordx4 v11, s[16:19], s29 offen lds
    ds_read_b64_tr_b16 v[72:73], v62 offset:64
    ds_read_b64_tr_b16 v[74:75], v62 offset:1856
    v_mfma_f32_32x32x16_bf16 a[80:95], v[84:87], v[24:27], a[80:95]
    ds_read_b64_tr_b16 v[76:77], v62 offset:96
    ds_read_b64_tr_b16 v[78:79], v62 offset:1888
    v_mfma_f32_32x32x16_bf16 a[96:111], v[88:91], v[24:27], a[96:111]
    buffer_load_dwordx4 v[24:27], v4, s[12:15], s36 offen offset:3072
    s_add_u32 s36, s36, 4096
    s_add_u32 s29, s29, 229376
    s_add_u32 s30, s30, 28928
    s_sub_u32 s28, s30, s39
    s_cmp_ge_u32 s28, 144640
    s_cselect_b32 s30, s39, s30
    ds_read_b64_tr_b16 v[80:81], v62 offset:128
    ds_read_b64_tr_b16 v[82:83], v62 offset:1920
    s_waitcnt vmcnt(19) lgkmcnt(8)
    v_mfma_f32_32x32x16_bf16 a[0:15], v[64:67], v[28:31], a[0:15]
    ds_read_b64_tr_b16 v[84:85], v62 offset:160
    ds_read_b64_tr_b16 v[86:87], v62 offset:1952
    s_waitcnt lgkmcnt(8)
    v_mfma_f32_32x32x16_bf16 a[16:31], v[68:71], v[28:31], a[16:31]
    s_add_u32 m0, s30, 0
    s_nop 0
    buffer_load_dwordx4 v5, s[16:19], s29 offen lds
    ds_read_b64_tr_b16 v[88:89], v62 offset:192
    ds_read_b64_tr_b16 v[90:91], v62 offset:1984
    s_waitcnt lgkmcnt(8)
    v_mfma_f32_32x32x16_bf16 a[32:47], v[72:75], v[28:31], a[32:47]
    ds_read_b64_tr_b16 v[64:65], v62 offset:3584
    ds_read_b64_tr_b16 v[66:67], v62 offset:5376
    s_waitcnt lgkmcnt(8)
    v_mfma_f32_32x32x16_bf16 a[48:63], v[76:79], v[28:31], a[48:63]
    ds_read_b64_tr_b16 v[68:69], v62 offset:3616
    ds_read_b64_tr_b16 v[70:71], v62 offset:5408
    s_waitcnt lgkmcnt(8)
    v_mfma_f32_32x32x16_bf16 a[64:79], v[80:83], v[28:31], a[64:79]
    ds_read_b64_tr_b16 v[72:73], v62 offset:3648
    ds_read_b64_tr_b16 v[74:75], v62 offset:5440
    s_waitcnt lgkmcnt(8)
    v_mfma_f32_32x32x16_bf16 a[80:95], v[84:87], v[28:31], a[80:95]
    s_add_u32 m0, s30, 1024
    s_nop 0
    buffer_load_dwordx4 v6, s[16:19], s29 offen lds
    ds_read_b64_tr_b16 v[76:77], v62 offset:3680
    ds_read_b64_tr_b16 v[78:79], v62 offset:5472
    s_waitcnt lgkmcnt(8)
    v_mfma_f32_32x32x16_bf16 a[96:111], v[88:91], v[28:31], a[96:111]
    buffer_load_dwordx4 v[28:31], v4, s[12:15], s36 offen offset:0
    ds_read_b64_tr_b16 v[80:81], v62 offset:3712
    ds_read_b64_tr_b16 v[82:83], v62 offset:5504
    s_waitcnt vmcnt(19) lgkmcnt(8)
    v_mfma_f32_32x32x16_bf16 a[0:15], v[64:67], v[32:35], a[0:15]
    ds_read_b64_tr_b16 v[84:85], v62 offset:3744
    ds_read_b64_tr_b16 v[86:87], v62 offset:5536
    s_waitcnt lgkmcnt(8)
    v_mfma_f32_32x32x16_bf16 a[16:31], v[68:71], v[32:35], a[16:31]
    ds_read_b64_tr_b16 v[88:89], v62 offset:3776
    ds_read_b64_tr_b16 v[90:91], v62 offset:5568
    s_waitcnt lgkmcnt(8)
    v_mfma_f32_32x32x16_bf16 a[32:47], v[72:75], v[32:35], a[32:47]
    s_add_u32 m0, s30, 2048
    s_nop 0
    buffer_load_dwordx4 v7, s[16:19], s29 offen lds
    ds_read_b64_tr_b16 v[64:65], v62 offset:7168
    ds_read_b64_tr_b16 v[66:67], v62 offset:8960
    s_waitcnt lgkmcnt(8)
    v_mfma_f32_32x32x16_bf16 a[48:63], v[76:79], v[32:35], a[48:63]
    ds_read_b64_tr_b16 v[68:69], v62 offset:7200
    ds_read_b64_tr_b16 v[70:71], v62 offset:8992
    s_waitcnt lgkmcnt(8)
    v_mfma_f32_32x32x16_bf16 a[64:79], v[80:83], v[32:35], a[64:79]
    ds_read_b64_tr_b16 v[72:73], v62 offset:7232
    ds_read_b64_tr_b16 v[74:75], v62 offset:9024
    s_waitcnt lgkmcnt(8)
    v_mfma_f32_32x32x16_bf16 a[80:95], v[84:87], v[32:35], a[80:95]
    ds_read_b64_tr_b16 v[76:77], v62 offset:7264
    ds_read_b64_tr_b16 v[78:79], v62 offset:9056
    s_waitcnt lgkmcnt(8)
    v_mfma_f32_32x32x16_bf16 a[96:111], v[88:91], v[32:35], a[96:111]
    s_add_u32 m0, s30, 3072
    s_nop 0
    buffer_load_dwordx4 v8, s[16:19], s29 offen lds
    buffer_load_dwordx4 v[32:35], v4, s[12:15], s36 offen offset:1024
    ds_read_b64_tr_b16 v[80:81], v62 offset:7296
    ds_read_b64_tr_b16 v[82:83], v62 offset:9088
    s_waitcnt vmcnt(20) lgkmcnt(8)
    v_mfma_f32_32x32x16_bf16 a[0:15], v[64:67], v[36:39], a[0:15]
    ds_read_b64_tr_b16 v[84:85], v62 offset:7328
    ds_read_b64_tr_b16 v[86:87], v62 offset:9120
    s_waitcnt lgkmcnt(8)
    v_mfma_f32_32x32x16_bf16 a[16:31], v[68:71], v[36:39], a[16:31]
    ds_read_b64_tr_b16 v[88:89], v62 offset:7360
    ds_read_b64_tr_b16 v[90:91], v62 offset:9152
    s_waitcnt lgkmcnt(8)
    v_mfma_f32_32x32x16_bf16 a[32:47], v[72:75], v[36:39], a[32:47]
    ds_read_b64_tr_b16 v[64:65], v62 offset:10752
    ds_read_b64_tr_b16 v[66:67], v62 offset:12544
    s_waitcnt lgkmcnt(8)
    v_mfma_f32_32x32x16_bf16 a[48:63], v[76:79], v[36:39], a[48:63]
    s_add_u32 m0, s30, 4096
    s_nop 0
    buffer_load_dwordx4 v9, s[16:19], s29 offen lds
    ds_read_b64_tr_b16 v[68:69], v62 offset:10784
    ds_read_b64_tr_b16 v[70:71], v62 offset:12576
    s_waitcnt lgkmcnt(8)
    v_mfma_f32_32x32x16_bf16 a[64:79], v[80:83], v[36:39], a[64:79]
    ds_read_b64_tr_b16 v[72:73], v62 offset:10816
    ds_read_b64_tr_b16 v[74:75], v62 offset:12608
    s_waitcnt lgkmcnt(8)
    v_mfma_f32_32x32x16_bf16 a[80:95], v[84:87], v[36:39], a[80:95]
    ds_read_b64_tr_b16 v[76:77], v62 offset:10848
    ds_read_b64_tr_b16 v[78:79], v62 offset:12640
    s_waitcnt lgkmcnt(8)
    v_mfma_f32_32x32x16_bf16 a[96:111], v[88:91], v[36:39], a[96:111]
    buffer_load_dwordx4 v[36:39], v4, s[12:15], s36 offen offset:2048
    ds_read_b64_tr_b16 v[80:81], v62 offset:10880
    ds_read_b64_tr_b16 v[82:83], v62 offset:12672
    s_waitcnt vmcnt(19) lgkmcnt(8)
    v_mfma_f32_32x32x16_bf16 a[0:15], v[64:67], v[40:43], a[0:15]
    s_add_u32 m0, s30, 5120
    s_nop 0
    buffer_load_dwordx4 v10, s[16:19], s29 offen lds
    ds_read_b64_tr_b16 v[84:85], v62 offset:10912
    ds_read_b64_tr_b16 v[86:87], v62 offset:12704
    s_waitcnt lgkmcnt(8)
    v_mfma_f32_32x32x16_bf16 a[16:31], v[68:71], v[40:43], a[16:31]
    ds_read_b64_tr_b16 v[88:89], v62 offset:10944
    ds_read_b64_tr_b16 v[90:91], v62 offset:12736
    s_waitcnt lgkmcnt(8)
    v_mfma_f32_32x32x16_bf16 a[32:47], v[72:75], v[40:43], a[32:47]
    s_waitcnt lgkmcnt(0)
    s_barrier
    s_add_u32 s38, s38, 28928
    s_cmp_ge_u32 s38, 144640
    s_cselect_b32 s38, 0, s38
    v_add_u32 v61, s38, v60
    ds_read_b64_tr_b16 v[64:65], v61 offset:0
    ds_read_b64_tr_b16 v[66:67], v61 offset:1792
    v_mfma_f32_32x32x16_bf16 a[48:63], v[76:79], v[40:43], a[48:63]
    ds_read_b64_tr_b16 v[68:69], v61 offset:32
    ds_read_b64_tr_b16 v[70:71], v61 offset:1824
    v_mfma_f32_32x32x16_bf16 a[64:79], v[80:83], v[40:43], a[64:79]
    s_add_u32 m0, s30, 6144
    s_nop 0
    buffer_load_dwordx4 v11, s[16:19], s29 offen lds
    ds_read_b64_tr_b16 v[72:73], v61 offset:64
    ds_read_b64_tr_b16 v[74:75], v61 offset:1856
    v_mfma_f32_32x32x16_bf16 a[80:95], v[84:87], v[40:43], a[80:95]
    ds_read_b64_tr_b16 v[76:77], v61 offset:96
    ds_read_b64_tr_b16 v[78:79], v61 offset:1888
    v_mfma_f32_32x32x16_bf16 a[96:111], v[88:91], v[40:43], a[96:111]
    buffer_load_dwordx4 v[40:43], v4, s[12:15], s36 offen offset:3072
    s_add_u32 s36, s36, 4096
    s_add_u32 s29, s29, 229376
    s_add_u32 s30, s30, 28928
    s_sub_u32 s28, s30, s39
    s_cmp_ge_u32 s28, 144640
    s_cselect_b32 s30, s39, s30
    s_waitcnt lgkmcnt(0)
    s_add_u32 s37, s37, 1
    s_cmp_lt_u32 s37, 4
    s_cbranch_scc1 L_k4_loop
    s_waitcnt vmcnt(0)
    s_mov_b32 s44, s40
    s_mov_b32 s45, s41
    s_and_b32 s45, s45, 0xffff
    s_mov_b32 s46, 1835008
    s_mov_b32 s47, 0x00020000
    s_lshl_b32 s27, s26, 6
    v_add_u32 v92, s27, v1
    v_lshrrev_b32 v2, 2, v92
    v_lshlrev_b32 v2, 10, v2
    v_and_b32 v92, 3, v92
    v_lshl_add_u32 v92, v92, 7, v2
    s_lshr_b32 s27, s2, 3
    s_mul_i32 s27, s27, 57344
    s_bfe_u32 s28, s2, 0x10002
    s_lshl_b32 s28, s28, 9
    s_add_u32 s27, s27, s28
    buffer_load_dword v93, v92, s[44:47], s27 offen
    v_add_f32 v94, v44, v46
    v_add_f32 v94, v94, v48
    v_add_f32 v94, v94, v50
    v_add_f32 v94, v94, v52
    v_add_f32 v94, v94, v54
    v_add_f32 v94, v94, v56
    v_add_f32 v94, v94, v58
    v_mov_b32 v2, v94
    v_mov_b32 v3, v94
    s_nop 1
    v_permlane32_swap_b32 v2, v3
    v_add_f32 v94, v2, v3
    v_mul_f32 v102, 0x3d800000, v94
    v_mul_f32 v94, 0x3b000000, v94
    v_mov_b32 v98, 0
    v_mov_b32 v103, 0
    v_sub_f32 v2, v44, v102
    v_fmac_f32 v103, v2, v2
    v_add_f32 v98, v98, v45
    v_sub_f32 v2, v46, v102
    v_fmac_f32 v103, v2, v2
    v_add_f32 v98, v98, v47
    v_sub_f32 v2, v48, v102
    v_fmac_f32 v103, v2, v2
    v_add_f32 v98, v98, v49
    v_sub_f32 v2, v50, v102
    v_fmac_f32 v103, v2, v2
    v_add_f32 v98, v98, v51
    v_sub_f32 v2, v52, v102
    v_fmac_f32 v103, v2, v2
    v_add_f32 v98, v98, v53
    v_sub_f32 v2, v54, v102
    v_fmac_f32 v103, v2, v2
    v_add_f32 v98, v98, v55
    v_sub_f32 v2, v56, v102
    v_fmac_f32 v103, v2, v2
    v_add_f32 v98, v98, v57
    v_sub_f32 v2, v58, v102
    v_fmac_f32 v103, v2, v2
    v_add_f32 v98, v98, v59
    v_fmac_f32 v98, 0x3d000000, v103
    v_mov_b32 v2, v98
    v_mov_b32 v3, v98
    s_nop 1
    v_permlane32_swap_b32 v2, v3
    v_add_f32 v98, v2, v3
    v_mul_f32 v98, 0x3b000000, v98
    v_cvt_pk_bf16_f32 v2, v94, v94
    v_and_b32 v96, 0xffff0000, v2
    v_sub_f32 v96, 0, v96
    v_mov_b32 v97, v96
    v_cvt_pk_bf16_f32 v2, v98, v98
    v_and_b32 v98, 0xffff0000, v2
    v_add_f32 v98, 0x3727c5ac, v98
    v_cvt_pk_bf16_f32 v2, v98, v98
    v_and_b32 v98, 0xffff0000, v2
    v_sqrt_f32 v98, v98
    s_nop 0
    v_cvt_pk_bf16_f32 v2, v98, v98
    v_and_b32 v98, 0xffff0000, v2
    v_rcp_f32 v100, v98
    s_nop 0
    v_mov_b32 v101, v100
    s_add_u32 s20, s4, 10485760
    s_addc_u32 s21, s5, 0
    s_and_b32 s21, s21, 0xffff
    s_mov_b32 s22, 7340032
    s_mov_b32 s23, 0x00020000
    s_mul_i32 s27, s31, 112
    s_mul_i32 s28, s25, 7
    s_add_u32 s27, s27, s28
    s_lshl_b32 s27, s27, 10
    v_lshrrev_b32 v152, 5, v1
    v_lshlrev_b32 v152, 4, v152
    v_add_u32 v152, 144640, v152
    ds_read_b128 v[120:123], v152 offset:0
    ds_read_b128 v[124:127], v152 offset:32
    ds_read_b128 v[128:131], v152 offset:512
    ds_read_b128 v[132:135], v152 offset:544
    ds_read_b128 v[136:139], v152 offset:64
    ds_read_b128 v[140:143], v152 offset:96
    ds_read_b128 v[144:147], v152 offset:576
    ds_read_b128 v[148:151], v152 offset:608
    v_accvgpr_read_b32 v28, a0
    v_accvgpr_read_b32 v104, a8
    v_accvgpr_read_b32 v29, a1
    v_accvgpr_read_b32 v105, a9
    v_accvgpr_read_b32 v30, a2
    v_accvgpr_read_b32 v106, a10
    v_accvgpr_read_b32 v31, a3
    v_accvgpr_read_b32 v107, a11
    v_accvgpr_read_b32 v32, a4
    v_accvgpr_read_b32 v108, a12
    v_accvgpr_read_b32 v33, a5
    v_accvgpr_read_b32 v109, a13
    v_accvgpr_read_b32 v34, a6
    v_accvgpr_read_b32 v110, a14
    v_accvgpr_read_b32 v35, a7
    v_accvgpr_read_b32 v111, a15
    s_waitcnt lgkmcnt(7)
    v_pk_fma_f32 v[28:29], v[120:121], v[96:97], v[28:29]
    v_pk_mul_f32 v[28:29], v[28:29], v[100:101]
    v_pk_fma_f32 v[30:31], v[122:123], v[96:97], v[30:31]
    v_pk_mul_f32 v[30:31], v[30:31], v[100:101]
    s_waitcnt lgkmcnt(6)
    v_pk_fma_f32 v[32:33], v[124:125], v[96:97], v[32:33]
    v_pk_mul_f32 v[32:33], v[32:33], v[100:101]
    v_pk_fma_f32 v[34:35], v[126:127], v[96:97], v[34:35]
    v_pk_mul_f32 v[34:35], v[34:35], v[100:101]
    s_waitcnt lgkmcnt(5)
    v_pk_fma_f32 v[104:105], v[128:129], v[96:97], v[104:105]
    v_pk_mul_f32 v[104:105], v[104:105], v[100:101]
    v_pk_fma_f32 v[106:107], v[130:131], v[96:97], v[106:107]
    v_pk_mul_f32 v[106:107], v[106:107], v[100:101]
    s_waitcnt lgkmcnt(4)
    v_pk_fma_f32 v[108:109], v[132:133], v[96:97], v[108:109]
    v_pk_mul_f32 v[108:109], v[108:109], v[100:101]
    v_pk_fma_f32 v[110:111], v[134:135], v[96:97], v[110:111]
    v_pk_mul_f32 v[110:111], v[110:111], v[100:101]
    v_max_f32 v28, 0, v28
    v_max_f32 v29, 0, v29
    v_max_f32 v30, 0, v30
    v_max_f32 v31, 0, v31
    v_max_f32 v32, 0, v32
    v_max_f32 v33, 0, v33
    v_max_f32 v34, 0, v34
    v_max_f32 v35, 0, v35
    v_pk_mul_f32 v[28:29], v[28:29], v[104:105]
    v_pk_mul_f32 v[30:31], v[30:31], v[106:107]
    v_pk_mul_f32 v[32:33], v[32:33], v[108:109]
    v_pk_mul_f32 v[34:35], v[34:35], v[110:111]
    v_cvt_pk_bf16_f32 v12, v28, v29
    v_cvt_pk_bf16_f32 v13, v30, v31
    v_cvt_pk_bf16_f32 v14, v32, v33
    v_cvt_pk_bf16_f32 v15, v34, v35
    s_add_u32 s28, s27, 0
    buffer_store_dwordx4 v[12:15], v4, s[20:23], s28 offen
    ds_read_b128 v[120:123], v152 offset:128
    ds_read_b128 v[124:127], v152 offset:160
    ds_read_b128 v[128:131], v152 offset:640
    ds_read_b128 v[132:135], v152 offset:672
    v_accvgpr_read_b32 v28, a16
    v_accvgpr_read_b32 v104, a24
    v_accvgpr_read_b32 v29, a17
    v_accvgpr_read_b32 v105, a25
    v_accvgpr_read_b32 v30, a18
    v_accvgpr_read_b32 v106, a26
    v_accvgpr_read_b32 v31, a19
    v_accvgpr_read_b32 v107, a27
    v_accvgpr_read_b32 v32, a20
    v_accvgpr_read_b32 v108, a28
    v_accvgpr_read_b32 v33, a21
    v_accvgpr_read_b32 v109, a29
    v_accvgpr_read_b32 v34, a22
    v_accvgpr_read_b32 v110, a30
    v_accvgpr_read_b32 v35, a23
    v_accvgpr_read_b32 v111, a31
    s_waitcnt lgkmcnt(7)
    v_pk_fma_f32 v[28:29], v[136:137], v[96:97], v[28:29]
    v_pk_mul_f32 v[28:29], v[28:29], v[100:101]
    v_pk_fma_f32 v[30:31], v[138:139], v[96:97], v[30:31]
    v_pk_mul_f32 v[30:31], v[30:31], v[100:101]
    s_waitcnt lgkmcnt(6)
    v_pk_fma_f32 v[32:33], v[140:141], v[96:97], v[32:33]
    v_pk_mul_f32 v[32:33], v[32:33], v[100:101]
    v_pk_fma_f32 v[34:35], v[142:143], v[96:97], v[34:35]
    v_pk_mul_f32 v[34:35], v[34:35], v[100:101]
    s_waitcnt lgkmcnt(5)
    v_pk_fma_f32 v[104:105], v[144:145], v[96:97], v[104:105]
    v_pk_mul_f32 v[104:105], v[104:105], v[100:101]
    v_pk_fma_f32 v[106:107], v[146:147], v[96:97], v[106:107]
    v_pk_mul_f32 v[106:107], v[106:107], v[100:101]
    s_waitcnt lgkmcnt(4)
    v_pk_fma_f32 v[108:109], v[148:149], v[96:97], v[108:109]
    v_pk_mul_f32 v[108:109], v[108:109], v[100:101]
    v_pk_fma_f32 v[110:111], v[150:151], v[96:97], v[110:111]
    v_pk_mul_f32 v[110:111], v[110:111], v[100:101]
    v_max_f32 v28, 0, v28
    v_max_f32 v29, 0, v29
    v_max_f32 v30, 0, v30
    v_max_f32 v31, 0, v31
    v_max_f32 v32, 0, v32
    v_max_f32 v33, 0, v33
    v_max_f32 v34, 0, v34
    v_max_f32 v35, 0, v35
    v_pk_mul_f32 v[28:29], v[28:29], v[104:105]
    v_pk_mul_f32 v[30:31], v[30:31], v[106:107]
    v_pk_mul_f32 v[32:33], v[32:33], v[108:109]
    v_pk_mul_f32 v[34:35], v[34:35], v[110:111]
    v_cvt_pk_bf16_f32 v20, v28, v29
    v_cvt_pk_bf16_f32 v21, v30, v31
    v_cvt_pk_bf16_f32 v22, v32, v33
    v_cvt_pk_bf16_f32 v23, v34, v35
    s_add_u32 s28, s27, 1024
    buffer_store_dwordx4 v[20:23], v4, s[20:23], s28 offen
    ds_read_b128 v[136:139], v152 offset:192
    ds_read_b128 v[140:143], v152 offset:224
    ds_read_b128 v[144:147], v152 offset:704
    ds_read_b128 v[148:151], v152 offset:736
    v_accvgpr_read_b32 v28, a32
    v_accvgpr_read_b32 v104, a40
    v_accvgpr_read_b32 v29, a33
    v_accvgpr_read_b32 v105, a41
    v_accvgpr_read_b32 v30, a34
    v_accvgpr_read_b32 v106, a42
    v_accvgpr_read_b32 v31, a35
    v_accvgpr_read_b32 v107, a43
    v_accvgpr_read_b32 v32, a36
    v_accvgpr_read_b32 v108, a44
    v_accvgpr_read_b32 v33, a37
    v_accvgpr_read_b32 v109, a45
    v_accvgpr_read_b32 v34, a38
    v_accvgpr_read_b32 v110, a46
    v_accvgpr_read_b32 v35, a39
    v_accvgpr_read_b32 v111, a47
    s_waitcnt lgkmcnt(7)
    v_pk_fma_f32 v[28:29], v[120:121], v[96:97], v[28:29]
    v_pk_mul_f32 v[28:29], v[28:29], v[100:101]
    v_pk_fma_f32 v[30:31], v[122:123], v[96:97], v[30:31]
    v_pk_mul_f32 v[30:31], v[30:31], v[100:101]
    s_waitcnt lgkmcnt(6)
    v_pk_fma_f32 v[32:33], v[124:125], v[96:97], v[32:33]
    v_pk_mul_f32 v[32:33], v[32:33], v[100:101]
    v_pk_fma_f32 v[34:35], v[126:127], v[96:97], v[34:35]
    v_pk_mul_f32 v[34:35], v[34:35], v[100:101]
    s_waitcnt lgkmcnt(5)
    v_pk_fma_f32 v[104:105], v[128:129], v[96:97], v[104:105]
    v_pk_mul_f32 v[104:105], v[104:105], v[100:101]
    v_pk_fma_f32 v[106:107], v[130:131], v[96:97], v[106:107]
    v_pk_mul_f32 v[106:107], v[106:107], v[100:101]
    s_waitcnt lgkmcnt(4)
    v_pk_fma_f32 v[108:109], v[132:133], v[96:97], v[108:109]
    v_pk_mul_f32 v[108:109], v[108:109], v[100:101]
    v_pk_fma_f32 v[110:111], v[134:135], v[96:97], v[110:111]
    v_pk_mul_f32 v[110:111], v[110:111], v[100:101]
    v_max_f32 v28, 0, v28
    v_max_f32 v29, 0, v29
    v_max_f32 v30, 0, v30
    v_max_f32 v31, 0, v31
    v_max_f32 v32, 0, v32
    v_max_f32 v33, 0, v33
    v_max_f32 v34, 0, v34
    v_max_f32 v35, 0, v35
    v_pk_mul_f32 v[28:29], v[28:29], v[104:105]
    v_pk_mul_f32 v[30:31], v[30:31], v[106:107]
    v_pk_mul_f32 v[32:33], v[32:33], v[108:109]
    v_pk_mul_f32 v[34:35], v[34:35], v[110:111]
    v_cvt_pk_bf16_f32 v12, v28, v29
    v_cvt_pk_bf16_f32 v13, v30, v31
    v_cvt_pk_bf16_f32 v14, v32, v33
    v_cvt_pk_bf16_f32 v15, v34, v35
    s_add_u32 s28, s27, 2048
    buffer_store_dwordx4 v[12:15], v4, s[20:23], s28 offen
    ds_read_b128 v[120:123], v152 offset:256
    ds_read_b128 v[124:127], v152 offset:288
    ds_read_b128 v[128:131], v152 offset:768
    ds_read_b128 v[132:135], v152 offset:800
    v_accvgpr_read_b32 v28, a48
    v_accvgpr_read_b32 v104, a56
    v_accvgpr_read_b32 v29, a49
    v_accvgpr_read_b32 v105, a57
    v_accvgpr_read_b32 v30, a50
    v_accvgpr_read_b32 v106, a58
    v_accvgpr_read_b32 v31, a51
    v_accvgpr_read_b32 v107, a59
    v_accvgpr_read_b32 v32, a52
    v_accvgpr_read_b32 v108, a60
    v_accvgpr_read_b32 v33, a53
    v_accvgpr_read_b32 v109, a61
    v_accvgpr_read_b32 v34, a54
    v_accvgpr_read_b32 v110, a62
    v_accvgpr_read_b32 v35, a55
    v_accvgpr_read_b32 v111, a63
    s_waitcnt lgkmcnt(7)
    v_pk_fma_f32 v[28:29], v[136:137], v[96:97], v[28:29]
    v_pk_mul_f32 v[28:29], v[28:29], v[100:101]
    v_pk_fma_f32 v[30:31], v[138:139], v[96:97], v[30:31]
    v_pk_mul_f32 v[30:31], v[30:31], v[100:101]
    s_waitcnt lgkmcnt(6)
    v_pk_fma_f32 v[32:33], v[140:141], v[96:97], v[32:33]
    v_pk_mul_f32 v[32:33], v[32:33], v[100:101]
    v_pk_fma_f32 v[34:35], v[142:143], v[96:97], v[34:35]
    v_pk_mul_f32 v[34:35], v[34:35], v[100:101]
    s_waitcnt lgkmcnt(5)
    v_pk_fma_f32 v[104:105], v[144:145], v[96:97], v[104:105]
    v_pk_mul_f32 v[104:105], v[104:105], v[100:101]
    v_pk_fma_f32 v[106:107], v[146:147], v[96:97], v[106:107]
    v_pk_mul_f32 v[106:107], v[106:107], v[100:101]
    s_waitcnt lgkmcnt(4)
    v_pk_fma_f32 v[108:109], v[148:149], v[96:97], v[108:109]
    v_pk_mul_f32 v[108:109], v[108:109], v[100:101]
    v_pk_fma_f32 v[110:111], v[150:151], v[96:97], v[110:111]
    v_pk_mul_f32 v[110:111], v[110:111], v[100:101]
    v_max_f32 v28, 0, v28
    v_max_f32 v29, 0, v29
    v_max_f32 v30, 0, v30
    v_max_f32 v31, 0, v31
    v_max_f32 v32, 0, v32
    v_max_f32 v33, 0, v33
    v_max_f32 v34, 0, v34
    v_max_f32 v35, 0, v35
    v_pk_mul_f32 v[28:29], v[28:29], v[104:105]
    v_pk_mul_f32 v[30:31], v[30:31], v[106:107]
    v_pk_mul_f32 v[32:33], v[32:33], v[108:109]
    v_pk_mul_f32 v[34:35], v[34:35], v[110:111]
    v_cvt_pk_bf16_f32 v20, v28, v29
    v_cvt_pk_bf16_f32 v21, v30, v31
    v_cvt_pk_bf16_f32 v22, v32, v33
    v_cvt_pk_bf16_f32 v23, v34, v35
    s_add_u32 s28, s27, 3072
    buffer_store_dwordx4 v[20:23], v4, s[20:23], s28 offen
    ds_read_b128 v[136:139], v152 offset:320
    ds_read_b128 v[140:143], v152 offset:352
    ds_read_b128 v[144:147], v152 offset:832
    ds_read_b128 v[148:151], v152 offset:864
    v_accvgpr_read_b32 v28, a64
    v_accvgpr_read_b32 v104, a72
    v_accvgpr_read_b32 v29, a65
    v_accvgpr_read_b32 v105, a73
    v_accvgpr_read_b32 v30, a66
    v_accvgpr_read_b32 v106, a74
    v_accvgpr_read_b32 v31, a67
    v_accvgpr_read_b32 v107, a75
    v_accvgpr_read_b32 v32, a68
    v_accvgpr_read_b32 v108, a76
    v_accvgpr_read_b32 v33, a69
    v_accvgpr_read_b32 v109, a77
    v_accvgpr_read_b32 v34, a70
    v_accvgpr_read_b32 v110, a78
    v_accvgpr_read_b32 v35, a71
    v_accvgpr_read_b32 v111, a79
    s_waitcnt lgkmcnt(7)
    v_pk_fma_f32 v[28:29], v[120:121], v[96:97], v[28:29]
    v_pk_mul_f32 v[28:29], v[28:29], v[100:101]
    v_pk_fma_f32 v[30:31], v[122:123], v[96:97], v[30:31]
    v_pk_mul_f32 v[30:31], v[30:31], v[100:101]
    s_waitcnt lgkmcnt(6)
    v_pk_fma_f32 v[32:33], v[124:125], v[96:97], v[32:33]
    v_pk_mul_f32 v[32:33], v[32:33], v[100:101]
    v_pk_fma_f32 v[34:35], v[126:127], v[96:97], v[34:35]
    v_pk_mul_f32 v[34:35], v[34:35], v[100:101]
    s_waitcnt lgkmcnt(5)
    v_pk_fma_f32 v[104:105], v[128:129], v[96:97], v[104:105]
    v_pk_mul_f32 v[104:105], v[104:105], v[100:101]
    v_pk_fma_f32 v[106:107], v[130:131], v[96:97], v[106:107]
    v_pk_mul_f32 v[106:107], v[106:107], v[100:101]
    s_waitcnt lgkmcnt(4)
    v_pk_fma_f32 v[108:109], v[132:133], v[96:97], v[108:109]
    v_pk_mul_f32 v[108:109], v[108:109], v[100:101]
    v_pk_fma_f32 v[110:111], v[134:135], v[96:97], v[110:111]
    v_pk_mul_f32 v[110:111], v[110:111], v[100:101]
    v_max_f32 v28, 0, v28
    v_max_f32 v29, 0, v29
    v_max_f32 v30, 0, v30
    v_max_f32 v31, 0, v31
    v_max_f32 v32, 0, v32
    v_max_f32 v33, 0, v33
    v_max_f32 v34, 0, v34
    v_max_f32 v35, 0, v35
    v_pk_mul_f32 v[28:29], v[28:29], v[104:105]
    v_pk_mul_f32 v[30:31], v[30:31], v[106:107]
    v_pk_mul_f32 v[32:33], v[32:33], v[108:109]
    v_pk_mul_f32 v[34:35], v[34:35], v[110:111]
    v_cvt_pk_bf16_f32 v12, v28, v29
    v_cvt_pk_bf16_f32 v13, v30, v31
    v_cvt_pk_bf16_f32 v14, v32, v33
    v_cvt_pk_bf16_f32 v15, v34, v35
    s_add_u32 s28, s27, 4096
    buffer_store_dwordx4 v[12:15], v4, s[20:23], s28 offen
    ds_read_b128 v[120:123], v152 offset:384
    ds_read_b128 v[124:127], v152 offset:416
    ds_read_b128 v[128:131], v152 offset:896
    ds_read_b128 v[132:135], v152 offset:928
    v_accvgpr_read_b32 v28, a80
    v_accvgpr_read_b32 v104, a88
    v_accvgpr_read_b32 v29, a81
    v_accvgpr_read_b32 v105, a89
    v_accvgpr_read_b32 v30, a82
    v_accvgpr_read_b32 v106, a90
    v_accvgpr_read_b32 v31, a83
    v_accvgpr_read_b32 v107, a91
    v_accvgpr_read_b32 v32, a84
    v_accvgpr_read_b32 v108, a92
    v_accvgpr_read_b32 v33, a85
    v_accvgpr_read_b32 v109, a93
    v_accvgpr_read_b32 v34, a86
    v_accvgpr_read_b32 v110, a94
    v_accvgpr_read_b32 v35, a87
    v_accvgpr_read_b32 v111, a95
    s_waitcnt lgkmcnt(7)
    v_pk_fma_f32 v[28:29], v[136:137], v[96:97], v[28:29]
    v_pk_mul_f32 v[28:29], v[28:29], v[100:101]
    v_pk_fma_f32 v[30:31], v[138:139], v[96:97], v[30:31]
    v_pk_mul_f32 v[30:31], v[30:31], v[100:101]
    s_waitcnt lgkmcnt(6)
    v_pk_fma_f32 v[32:33], v[140:141], v[96:97], v[32:33]
    v_pk_mul_f32 v[32:33], v[32:33], v[100:101]
    v_pk_fma_f32 v[34:35], v[142:143], v[96:97], v[34:35]
    v_pk_mul_f32 v[34:35], v[34:35], v[100:101]
    s_waitcnt lgkmcnt(5)
    v_pk_fma_f32 v[104:105], v[144:145], v[96:97], v[104:105]
    v_pk_mul_f32 v[104:105], v[104:105], v[100:101]
    v_pk_fma_f32 v[106:107], v[146:147], v[96:97], v[106:107]
    v_pk_mul_f32 v[106:107], v[106:107], v[100:101]
    s_waitcnt lgkmcnt(4)
    v_pk_fma_f32 v[108:109], v[148:149], v[96:97], v[108:109]
    v_pk_mul_f32 v[108:109], v[108:109], v[100:101]
    v_pk_fma_f32 v[110:111], v[150:151], v[96:97], v[110:111]
    v_pk_mul_f32 v[110:111], v[110:111], v[100:101]
    v_max_f32 v28, 0, v28
    v_max_f32 v29, 0, v29
    v_max_f32 v30, 0, v30
    v_max_f32 v31, 0, v31
    v_max_f32 v32, 0, v32
    v_max_f32 v33, 0, v33
    v_max_f32 v34, 0, v34
    v_max_f32 v35, 0, v35
    v_pk_mul_f32 v[28:29], v[28:29], v[104:105]
    v_pk_mul_f32 v[30:31], v[30:31], v[106:107]
    v_pk_mul_f32 v[32:33], v[32:33], v[108:109]
    v_pk_mul_f32 v[34:35], v[34:35], v[110:111]
    v_cvt_pk_bf16_f32 v20, v28, v29
    v_cvt_pk_bf16_f32 v21, v30, v31
    v_cvt_pk_bf16_f32 v22, v32, v33
    v_cvt_pk_bf16_f32 v23, v34, v35
    s_add_u32 s28, s27, 5120
    buffer_store_dwordx4 v[20:23], v4, s[20:23], s28 offen
    v_accvgpr_read_b32 v28, a96
    v_accvgpr_read_b32 v104, a104
    v_accvgpr_read_b32 v29, a97
    v_accvgpr_read_b32 v105, a105
    v_accvgpr_read_b32 v30, a98
    v_accvgpr_read_b32 v106, a106
    v_accvgpr_read_b32 v31, a99
    v_accvgpr_read_b32 v107, a107
    v_accvgpr_read_b32 v32, a100
    v_accvgpr_read_b32 v108, a108
    v_accvgpr_read_b32 v33, a101
    v_accvgpr_read_b32 v109, a109
    v_accvgpr_read_b32 v34, a102
    v_accvgpr_read_b32 v110, a110
    v_accvgpr_read_b32 v35, a103
    v_accvgpr_read_b32 v111, a111
    s_waitcnt lgkmcnt(3)
    v_pk_fma_f32 v[28:29], v[120:121], v[96:97], v[28:29]
    v_pk_mul_f32 v[28:29], v[28:29], v[100:101]
    v_pk_fma_f32 v[30:31], v[122:123], v[96:97], v[30:31]
    v_pk_mul_f32 v[30:31], v[30:31], v[100:101]
    s_waitcnt lgkmcnt(2)
    v_pk_fma_f32 v[32:33], v[124:125], v[96:97], v[32:33]
    v_pk_mul_f32 v[32:33], v[32:33], v[100:101]
    v_pk_fma_f32 v[34:35], v[126:127], v[96:97], v[34:35]
    v_pk_mul_f32 v[34:35], v[34:35], v[100:101]
    s_waitcnt lgkmcnt(1)
    v_pk_fma_f32 v[104:105], v[128:129], v[96:97], v[104:105]
    v_pk_mul_f32 v[104:105], v[104:105], v[100:101]
    v_pk_fma_f32 v[106:107], v[130:131], v[96:97], v[106:107]
    v_pk_mul_f32 v[106:107], v[106:107], v[100:101]
    s_waitcnt lgkmcnt(0)
    v_pk_fma_f32 v[108:109], v[132:133], v[96:97], v[108:109]
    v_pk_mul_f32 v[108:109], v[108:109], v[100:101]
    v_pk_fma_f32 v[110:111], v[134:135], v[96:97], v[110:111]
    v_pk_mul_f32 v[110:111], v[110:111], v[100:101]
    v_max_f32 v28, 0, v28
    v_max_f32 v29, 0, v29
    v_max_f32 v30, 0, v30
    v_max_f32 v31, 0, v31
    v_max_f32 v32, 0, v32
    v_max_f32 v33, 0, v33
    v_max_f32 v34, 0, v34
    v_max_f32 v35, 0, v35
    v_pk_mul_f32 v[28:29], v[28:29], v[104:105]
    v_pk_mul_f32 v[30:31], v[30:31], v[106:107]
    v_pk_mul_f32 v[32:33], v[32:33], v[108:109]
    v_pk_mul_f32 v[34:35], v[34:35], v[110:111]
    v_cvt_pk_bf16_f32 v12, v28, v29
    v_cvt_pk_bf16_f32 v13, v30, v31
    v_cvt_pk_bf16_f32 v14, v32, v33
    v_cvt_pk_bf16_f32 v15, v34, v35
    s_add_u32 s28, s27, 6144
    buffer_store_dwordx4 v[12:15], v4, s[20:23], s28 offen
    s_waitcnt vmcnt(0)
L_k4_end:
    s_endpgm
k4_ffn1_kernel_codeend:
.section .rodata,"a"
.p2align 6
.amdhsa_kernel k4_ffn1_kernel
  .amdhsa_next_free_vgpr 272
  .amdhsa_next_free_sgpr 56
  .amdhsa_accum_offset 156
  .amdhsa_group_segment_fixed_size 0
  .amdhsa_kernarg_size 80
  .amdhsa_user_sgpr_count 2
  .amdhsa_user_sgpr_kernarg_segment_ptr 1
  .amdhsa_system_sgpr_workgroup_id_x 1
.end_amdhsa_kernel
.text
.globl k5_down_kernel
.p2align 8
.type k5_down_kernel,@function
k5_down_kernel:

    s_cmp_ge_u32 s2, 256
    s_cbranch_scc1 L_k5_end
    s_load_dwordx2 s[4:5], s[0:1], 72
    s_load_dwordx2 s[6:7], s[0:1], 48
    s_load_dwordx2 s[10:11], s[0:1], 56
    v_and_b32 v1, 63, v0
    v_lshrrev_b32 v2, 6, v0
    s_nop 0
    v_readfirstlane_b32 s30, v2
    s_and_b32 s31, s2, 7
    s_lshr_b32 s32, s2, 3
    s_and_b32 s28, s31, 3
    s_lshl_b32 s28, s28, 3
    s_and_b32 s29, s32, 7
    s_add_u32 s28, s28, s29
    s_lshr_b32 s29, s31, 2
    s_lshl_b32 s29, s29, 2
    s_lshr_b32 s32, s32, 3
    s_add_u32 s29, s29, s32
    v_lshlrev_b32 v5, 4, v1
    v_lshrrev_b32 v2, 3, v1
    v_lshlrev_b32 v6, 10, v2
    v_bfe_u32 v2, v1, 4, 1
    v_lshlrev_b32 v2, 2, v2
    v_and_b32 v3, 7, v1
    v_xor_b32 v2, v2, v3
    v_lshl_add_u32 v6, v2, 4, v6
    s_waitcnt lgkmcnt(0)
    s_add_u32 s12, s4, 10485760
    s_addc_u32 s13, s5, 0
    s_and_b32 s13, s13, 0xffff
    s_mov_b32 s14, 7340032
    s_mov_b32 s15, 0x00020000
    s_mov_b32 s16, s6
    s_mov_b32 s17, s7
    s_and_b32 s17, s17, 0xffff
    s_mov_b32 s18, 1835008
    s_mov_b32 s19, 0x00020000
    s_mul_i32 s33, s28, 229376
    s_mul_i32 s31, s30, 28672
    s_add_u32 s33, s33, s31
    s_mul_i32 s34, s30, 458752
    s_lshl_b32 s31, s29, 7
    s_add_u32 s34, s34, s31
    s_mul_i32 s35, s30, 28672
    s_add_u32 s32, s33, 0
    buffer_load_dwordx4 v[8:11], v5, s[12:15], s32 offen
    s_add_u32 s32, s33, 114688
    buffer_load_dwordx4 v[12:15], v5, s[12:15], s32 offen
    s_add_u32 m0, s35, 0
    s_add_u32 s32, s34, 0
    buffer_load_dwordx4 v6, s[16:19], s32 offen lds
    s_add_u32 m0, s35, 1024
    s_add_u32 s32, s34, 8192
    buffer_load_dwordx4 v6, s[16:19], s32 offen lds
    s_add_u32 s32, s33, 1024
    buffer_load_dwordx4 v[16:19], v5, s[12:15], s32 offen
    s_add_u32 s32, s33, 115712
    buffer_load_dwordx4 v[20:23], v5, s[12:15], s32 offen
    s_add_u32 m0, s35, 2048
    s_add_u32 s32, s34, 16384
    buffer_load_dwordx4 v6, s[16:19], s32 offen lds
    s_add_u32 m0, s35, 3072
    s_add_u32 s32, s34, 24576
    buffer_load_dwordx4 v6, s[16:19], s32 offen lds
    s_add_u32 s32, s33, 2048
    buffer_load_dwordx4 v[24:27], v5, s[12:15], s32 offen
    s_add_u32 s32, s33, 116736
    buffer_load_dwordx4 v[28:31], v5, s[12:15], s32 offen
    s_add_u32 m0, s35, 4096
    s_add_u32 s32, s34, 32768
    buffer_load_dwordx4 v6, s[16:19], s32 offen lds
    s_add_u32 m0, s35, 5120
    s_add_u32 s32, s34, 40960
    buffer_load_dwordx4 v6, s[16:19], s32 offen lds
    s_add_u32 s32, s33, 3072
    buffer_load_dwordx4 v[32:35], v5, s[12:15], s32 offen
    s_add_u32 s32, s33, 117760
    buffer_load_dwordx4 v[36:39], v5, s[12:15], s32 offen
    s_add_u32 m0, s35, 6144
    s_add_u32 s32, s34, 49152
    buffer_load_dwordx4 v6, s[16:19], s32 offen lds
    s_add_u32 m0, s35, 7168
    s_add_u32 s32, s34, 57344
    buffer_load_dwordx4 v6, s[16:19], s32 offen lds
    s_add_u32 s32, s33, 4096
    buffer_load_dwordx4 v[40:43], v5, s[12:15], s32 offen
    s_add_u32 s32, s33, 118784
    buffer_load_dwordx4 v[44:47], v5, s[12:15], s32 offen
    s_add_u32 m0, s35, 8192
    s_add_u32 s32, s34, 65536
    buffer_load_dwordx4 v6, s[16:19], s32 offen lds
    s_add_u32 m0, s35, 9216
    s_add_u32 s32, s34, 73728
    buffer_load_dwordx4 v6, s[16:19], s32 offen lds
    s_add_u32 s32, s33, 5120
    buffer_load_dwordx4 v[48:51], v5, s[12:15], s32 offen
    s_add_u32 s32, s33, 119808
    buffer_load_dwordx4 v[52:55], v5, s[12:15], s32 offen
    s_add_u32 m0, s35, 10240
    s_add_u32 s32, s34, 81920
    buffer_load_dwordx4 v6, s[16:19], s32 offen lds
    s_add_u32 m0, s35, 11264
    s_add_u32 s32, s34, 90112
    buffer_load_dwordx4 v6, s[16:19], s32 offen lds
    s_add_u32 s32, s33, 6144
    buffer_load_dwordx4 v[56:59], v5, s[12:15], s32 offen
    s_add_u32 s32, s33, 120832
    buffer_load_dwordx4 v[60:63], v5, s[12:15], s32 offen
    s_add_u32 m0, s35, 12288
    s_add_u32 s32, s34, 98304
    buffer_load_dwordx4 v6, s[16:19], s32 offen lds
    s_add_u32 m0, s35, 13312
    s_add_u32 s32, s34, 106496
    buffer_load_dwordx4 v6, s[16:19], s32 offen lds
    s_add_u32 s32, s33, 7168
    buffer_load_dwordx4 v[64:67], v5, s[12:15], s32 offen
    s_add_u32 s32, s33, 121856
    buffer_load_dwordx4 v[68:71], v5, s[12:15], s32 offen
    s_add_u32 m0, s35, 14336
    s_add_u32 s32, s34, 114688
    buffer_load_dwordx4 v6, s[16:19], s32 offen lds
    s_add_u32 m0, s35, 15360
    s_add_u32 s32, s34, 122880
    buffer_load_dwordx4 v6, s[16:19], s32 offen lds
    s_add_u32 m0, s35, 16384
    s_add_u32 s32, s34, 131072
    buffer_load_dwordx4 v6, s[16:19], s32 offen lds
    s_add_u32 m0, s35, 17408
    s_add_u32 s32, s34, 139264
    buffer_load_dwordx4 v6, s[16:19], s32 offen lds
    s_add_u32 m0, s35, 18432
    s_add_u32 s32, s34, 147456
    buffer_load_dwordx4 v6, s[16:19], s32 offen lds
    s_add_u32 m0, s35, 19456
    s_add_u32 s32, s34, 155648
    buffer_load_dwordx4 v6, s[16:19], s32 offen lds
    s_add_u32 m0, s35, 20480
    s_add_u32 s32, s34, 163840
    buffer_load_dwordx4 v6, s[16:19], s32 offen lds
    s_add_u32 m0, s35, 21504
    s_add_u32 s32, s34, 172032
    buffer_load_dwordx4 v6, s[16:19], s32 offen lds
    s_add_u32 m0, s35, 22528
    s_add_u32 s32, s34, 180224
    buffer_load_dwordx4 v6, s[16:19], s32 offen lds
    s_add_u32 m0, s35, 23552
    s_add_u32 s32, s34, 188416
    buffer_load_dwordx4 v6, s[16:19], s32 offen lds
    s_add_u32 m0, s35, 24576
    s_add_u32 s32, s34, 196608
    buffer_load_dwordx4 v6, s[16:19], s32 offen lds
    s_add_u32 m0, s35, 25600
    s_add_u32 s32, s34, 204800
    buffer_load_dwordx4 v6, s[16:19], s32 offen lds
    s_add_u32 m0, s35, 26624
    s_add_u32 s32, s34, 212992
    buffer_load_dwordx4 v6, s[16:19], s32 offen lds
    s_add_u32 m0, s35, 27648
    s_add_u32 s32, s34, 221184
    buffer_load_dwordx4 v6, s[16:19], s32 offen lds
    s_lshr_b32 s31, s30, 1
    s_lshl_b32 s36, s28, 1
    s_add_u32 s36, s36, s31
    s_and_b32 s31, s30, 1
    s_lshl_b32 s37, s29, 1
    s_add_u32 s37, s37, s31
    s_add_u32 s20, s4, 8388608
    s_addc_u32 s21, s5, 0
    s_and_b32 s21, s21, 0xffff
    s_mov_b32 s22, 2097152
    s_mov_b32 s23, 0x00020000
    v_and_b32 v2, 31, v1
    v_lshlrev_b32 v88, 10, v2
    v_lshrrev_b32 v2, 5, v1
    v_lshl_add_u32 v88, v2, 3, v88
    s_lshl_b32 s31, s36, 15
    s_lshl_b32 s32, s37, 6
    s_add_u32 s38, s31, s32
    s_lshl_b32 s31, s36, 5
    s_lshl_b32 s32, s37, 1
    s_add_u32 s39, s31, s32
    s_lshl_b32 s39, s39, 10
    buffer_load_dwordx4 v[72:75], v5, s[20:23], s39 offen offset:0
    buffer_load_dwordx4 v[76:79], v5, s[20:23], s39 offen offset:1024
    v_lshrrev_b32 v2, 5, v1
    v_lshlrev_b32 v2, 2, v2
    v_bfe_u32 v3, v1, 2, 2
    v_add_u32 v2, v2, v3
    v_lshlrev_b32 v89, 7, v2
    v_bfe_u32 v2, v1, 4, 1
    v_lshlrev_b32 v2, 1, v2
    v_bfe_u32 v3, v1, 1, 1
    v_add_u32 v2, v2, v3
    v_bfe_u32 v3, v1, 3, 1
    v_lshlrev_b32 v3, 2, v3
    v_xor_b32 v2, v2, v3
    v_lshl_add_u32 v89, v2, 4, v89
    v_and_b32 v2, 1, v1
    v_lshl_add_u32 v89, v2, 3, v89
    v_add_u32 v89, s35, v89
    v_xor_b32 v90, 64, v89
    s_waitcnt vmcnt(42)
    ds_read_b64_tr_b16 v[92:93], v89 offset:0
    ds_read_b64_tr_b16 v[94:95], v89 offset:1024
    ds_read_b64_tr_b16 v[96:97], v90 offset:0
    ds_read_b64_tr_b16 v[98:99], v90 offset:1024
    s_waitcnt vmcnt(38)
    ds_read_b64_tr_b16 v[100:101], v89 offset:2048
    ds_read_b64_tr_b16 v[102:103], v89 offset:3072
    ds_read_b64_tr_b16 v[104:105], v90 offset:2048
    ds_read_b64_tr_b16 v[106:107], v90 offset:3072
    s_waitcnt lgkmcnt(6)
    v_mfma_f32_32x32x16_bf16 v[108:123], v[92:95], v[8:11], 0
    s_waitcnt lgkmcnt(4)
    v_mfma_f32_32x32x16_bf16 v[124:139], v[96:99], v[8:11], 0
    v_mfma_f32_32x32x16_bf16 v[140:155], v[92:95], v[12:15], 0
    v_mfma_f32_32x32x16_bf16 v[156:171], v[96:99], v[12:15], 0
    s_add_u32 s32, s33, 8192
    buffer_load_dwordx4 v[8:11], v5, s[12:15], s32 offen
    s_add_u32 s32, s33, 122880
    buffer_load_dwordx4 v[12:15], v5, s[12:15], s32 offen
    s_add_u32 m0, s35, 0
    s_add_u32 s32, s34, 229376
    buffer_load_dwordx4 v6, s[16:19], s32 offen lds
    s_add_u32 m0, s35, 1024
    s_add_u32 s32, s34, 237568
    buffer_load_dwordx4 v6, s[16:19], s32 offen lds
    s_waitcnt vmcnt(38)
    ds_read_b64_tr_b16 v[92:93], v89 offset:4096
    ds_read_b64_tr_b16 v[94:95], v89 offset:5120
    ds_read_b64_tr_b16 v[96:97], v90 offset:4096
    ds_read_b64_tr_b16 v[98:99], v90 offset:5120
    s_waitcnt lgkmcnt(6)
    v_mfma_f32_32x32x16_bf16 v[108:123], v[100:103], v[16:19], v[108:123]
    s_waitcnt lgkmcnt(4)
    v_mfma_f32_32x32x16_bf16 v[124:139], v[104:107], v[16:19], v[124:139]
    v_mfma_f32_32x32x16_bf16 v[140:155], v[100:103], v[20:23], v[140:155]
    v_mfma_f32_32x32x16_bf16 v[156:171], v[104:107], v[20:23], v[156:171]
    s_add_u32 s32, s33, 9216
    buffer_load_dwordx4 v[16:19], v5, s[12:15], s32 offen
    s_add_u32 s32, s33, 123904
    buffer_load_dwordx4 v[20:23], v5, s[12:15], s32 offen
    s_add_u32 m0, s35, 2048
    s_add_u32 s32, s34, 245760
    buffer_load_dwordx4 v6, s[16:19], s32 offen lds
    s_add_u32 m0, s35, 3072
    s_add_u32 s32, s34, 253952
    buffer_load_dwordx4 v6, s[16:19], s32 offen lds
    s_waitcnt vmcnt(38)
    ds_read_b64_tr_b16 v[100:101], v89 offset:6144
    ds_read_b64_tr_b16 v[102:103], v89 offset:7168
    ds_read_b64_tr_b16 v[104:105], v90 offset:6144
    ds_read_b64_tr_b16 v[106:107], v90 offset:7168
    s_waitcnt lgkmcnt(6)
    v_mfma_f32_32x32x16_bf16 v[108:123], v[92:95], v[24:27], v[108:123]
    s_waitcnt lgkmcnt(4)
    v_mfma_f32_32x32x16_bf16 v[124:139], v[96:99], v[24:27], v[124:139]
    v_mfma_f32_32x32x16_bf16 v[140:155], v[92:95], v[28:31], v[140:155]
    v_mfma_f32_32x32x16_bf16 v[156:171], v[96:99], v[28:31], v[156:171]
    s_add_u32 s32, s33, 10240
    buffer_load_dwordx4 v[24:27], v5, s[12:15], s32 offen
    s_add_u32 s32, s33, 124928
    buffer_load_dwordx4 v[28:31], v5, s[12:15], s32 offen
    s_add_u32 m0, s35, 4096
    s_add_u32 s32, s34, 262144
    buffer_load_dwordx4 v6, s[16:19], s32 offen lds
    s_add_u32 m0, s35, 5120
    s_add_u32 s32, s34, 270336
    buffer_load_dwordx4 v6, s[16:19], s32 offen lds
    s_waitcnt vmcnt(38)
    ds_read_b64_tr_b16 v[92:93], v89 offset:8192
    ds_read_b64_tr_b16 v[94:95], v89 offset:9216
    ds_read_b64_tr_b16 v[96:97], v90 offset:8192
    ds_read_b64_tr_b16 v[98:99], v90 offset:9216
    s_waitcnt lgkmcnt(6)
    v_mfma_f32_32x32x16_bf16 v[108:123], v[100:103], v[32:35], v[108:123]
    s_waitcnt lgkmcnt(4)
    v_mfma_f32_32x32x16_bf16 v[124:139], v[104:107], v[32:35], v[124:139]
    v_mfma_f32_32x32x16_bf16 v[140:155], v[100:103], v[36:39], v[140:155]
    v_mfma_f32_32x32x16_bf16 v[156:171], v[104:107], v[36:39], v[156:171]
    s_add_u32 s32, s33, 11264
    buffer_load_dwordx4 v[32:35], v5, s[12:15], s32 offen
    s_add_u32 s32, s33, 125952
    buffer_load_dwordx4 v[36:39], v5, s[12:15], s32 offen
    s_add_u32 m0, s35, 6144
    s_add_u32 s32, s34, 278528
    buffer_load_dwordx4 v6, s[16:19], s32 offen lds
    s_add_u32 m0, s35, 7168
    s_add_u32 s32, s34, 286720
    buffer_load_dwordx4 v6, s[16:19], s32 offen lds
    s_waitcnt vmcnt(38)
    ds_read_b64_tr_b16 v[100:101], v89 offset:10240
    ds_read_b64_tr_b16 v[102:103], v89 offset:11264
    ds_read_b64_tr_b16 v[104:105], v90 offset:10240
    ds_read_b64_tr_b16 v[106:107], v90 offset:11264
    s_waitcnt lgkmcnt(6)
    v_mfma_f32_32x32x16_bf16 v[108:123], v[92:95], v[40:43], v[108:123]
    s_waitcnt lgkmcnt(4)
    v_mfma_f32_32x32x16_bf16 v[124:139], v[96:99], v[40:43], v[124:139]
    v_mfma_f32_32x32x16_bf16 v[140:155], v[92:95], v[44:47], v[140:155]
    v_mfma_f32_32x32x16_bf16 v[156:171], v[96:99], v[44:47], v[156:171]
    s_add_u32 s32, s33, 12288
    buffer_load_dwordx4 v[40:43], v5, s[12:15], s32 offen
    s_add_u32 s32, s33, 126976
    buffer_load_dwordx4 v[44:47], v5, s[12:15], s32 offen
    s_add_u32 m0, s35, 8192
    s_add_u32 s32, s34, 294912
    buffer_load_dwordx4 v6, s[16:19], s32 offen lds
    s_add_u32 m0, s35, 9216
    s_add_u32 s32, s34, 303104
    buffer_load_dwordx4 v6, s[16:19], s32 offen lds
    s_waitcnt vmcnt(38)
    ds_read_b64_tr_b16 v[92:93], v89 offset:12288
    ds_read_b64_tr_b16 v[94:95], v89 offset:13312
    ds_read_b64_tr_b16 v[96:97], v90 offset:12288
    ds_read_b64_tr_b16 v[98:99], v90 offset:13312
    s_waitcnt lgkmcnt(6)
    v_mfma_f32_32x32x16_bf16 v[108:123], v[100:103], v[48:51], v[108:123]
    s_waitcnt lgkmcnt(4)
    v_mfma_f32_32x32x16_bf16 v[124:139], v[104:107], v[48:51], v[124:139]
    v_mfma_f32_32x32x16_bf16 v[140:155], v[100:103], v[52:55], v[140:155]
    v_mfma_f32_32x32x16_bf16 v[156:171], v[104:107], v[52:55], v[156:171]
    s_add_u32 s32, s33, 13312
    buffer_load_dwordx4 v[48:51], v5, s[12:15], s32 offen
    s_add_u32 s32, s33, 128000
    buffer_load_dwordx4 v[52:55], v5, s[12:15], s32 offen
    s_add_u32 m0, s35, 10240
    s_add_u32 s32, s34, 311296
    buffer_load_dwordx4 v6, s[16:19], s32 offen lds
    s_add_u32 m0, s35, 11264
    s_add_u32 s32, s34, 319488
    buffer_load_dwordx4 v6, s[16:19], s32 offen lds
    s_waitcnt vmcnt(38)
    ds_read_b64_tr_b16 v[100:101], v89 offset:14336
    ds_read_b64_tr_b16 v[102:103], v89 offset:15360
    ds_read_b64_tr_b16 v[104:105], v90 offset:14336
    ds_read_b64_tr_b16 v[106:107], v90 offset:15360
    s_waitcnt lgkmcnt(6)
    v_mfma_f32_32x32x16_bf16 v[108:123], v[92:95], v[56:59], v[108:123]
    s_waitcnt lgkmcnt(4)
    v_mfma_f32_32x32x16_bf16 v[124:139], v[96:99], v[56:59], v[124:139]
    v_mfma_f32_32x32x16_bf16 v[140:155], v[92:95], v[60:63], v[140:155]
    v_mfma_f32_32x32x16_bf16 v[156:171], v[96:99], v[60:63], v[156:171]
    s_add_u32 s32, s33, 14336
    buffer_load_dwordx4 v[56:59], v5, s[12:15], s32 offen
    s_add_u32 s32, s33, 129024
    buffer_load_dwordx4 v[60:63], v5, s[12:15], s32 offen
    s_add_u32 m0, s35, 12288
    s_add_u32 s32, s34, 327680
    buffer_load_dwordx4 v6, s[16:19], s32 offen lds
    s_add_u32 m0, s35, 13312
    s_add_u32 s32, s34, 335872
    buffer_load_dwordx4 v6, s[16:19], s32 offen lds
    s_waitcnt vmcnt(40)
    ds_read_b64_tr_b16 v[92:93], v89 offset:16384
    ds_read_b64_tr_b16 v[94:95], v89 offset:17408
    ds_read_b64_tr_b16 v[96:97], v90 offset:16384
    ds_read_b64_tr_b16 v[98:99], v90 offset:17408
    s_waitcnt lgkmcnt(6)
    v_mfma_f32_32x32x16_bf16 v[108:123], v[100:103], v[64:67], v[108:123]
    s_waitcnt lgkmcnt(4)
    v_mfma_f32_32x32x16_bf16 v[124:139], v[104:107], v[64:67], v[124:139]
    v_mfma_f32_32x32x16_bf16 v[140:155], v[100:103], v[68:71], v[140:155]
    v_mfma_f32_32x32x16_bf16 v[156:171], v[104:107], v[68:71], v[156:171]
    s_add_u32 s32, s33, 15360
    buffer_load_dwordx4 v[64:67], v5, s[12:15], s32 offen
    s_add_u32 s32, s33, 130048
    buffer_load_dwordx4 v[68:71], v5, s[12:15], s32 offen
    s_add_u32 m0, s35, 14336
    s_add_u32 s32, s34, 344064
    buffer_load_dwordx4 v6, s[16:19], s32 offen lds
    s_add_u32 m0, s35, 15360
    s_add_u32 s32, s34, 352256
    buffer_load_dwordx4 v6, s[16:19], s32 offen lds
    s_waitcnt vmcnt(42)
    ds_read_b64_tr_b16 v[100:101], v89 offset:18432
    ds_read_b64_tr_b16 v[102:103], v89 offset:19456
    ds_read_b64_tr_b16 v[104:105], v90 offset:18432
    ds_read_b64_tr_b16 v[106:107], v90 offset:19456
    s_waitcnt vmcnt(31) lgkmcnt(6)
    v_mfma_f32_32x32x16_bf16 v[108:123], v[92:95], v[8:11], v[108:123]
    s_waitcnt lgkmcnt(4)
    v_mfma_f32_32x32x16_bf16 v[124:139], v[96:99], v[8:11], v[124:139]
    s_waitcnt vmcnt(30)
    v_mfma_f32_32x32x16_bf16 v[140:155], v[92:95], v[12:15], v[140:155]
    v_mfma_f32_32x32x16_bf16 v[156:171], v[96:99], v[12:15], v[156:171]
    s_add_u32 s32, s33, 16384
    buffer_load_dwordx4 v[8:11], v5, s[12:15], s32 offen
    s_add_u32 s32, s33, 131072
    buffer_load_dwordx4 v[12:15], v5, s[12:15], s32 offen
    s_add_u32 m0, s35, 16384
    s_add_u32 s32, s34, 360448
    buffer_load_dwordx4 v6, s[16:19], s32 offen lds
    s_add_u32 m0, s35, 17408
    s_add_u32 s32, s34, 368640
    buffer_load_dwordx4 v6, s[16:19], s32 offen lds
    ds_read_b64_tr_b16 v[92:93], v89 offset:20480
    ds_read_b64_tr_b16 v[94:95], v89 offset:21504
    ds_read_b64_tr_b16 v[96:97], v90 offset:20480
    ds_read_b64_tr_b16 v[98:99], v90 offset:21504
    s_waitcnt vmcnt(31) lgkmcnt(6)
    v_mfma_f32_32x32x16_bf16 v[108:123], v[100:103], v[16:19], v[108:123]
    s_waitcnt lgkmcnt(4)
    v_mfma_f32_32x32x16_bf16 v[124:139], v[104:107], v[16:19], v[124:139]
    s_waitcnt vmcnt(30)
    v_mfma_f32_32x32x16_bf16 v[140:155], v[100:103], v[20:23], v[140:155]
    v_mfma_f32_32x32x16_bf16 v[156:171], v[104:107], v[20:23], v[156:171]
    s_add_u32 s32, s33, 17408
    buffer_load_dwordx4 v[16:19], v5, s[12:15], s32 offen
    s_add_u32 s32, s33, 132096
    buffer_load_dwordx4 v[20:23], v5, s[12:15], s32 offen
    s_add_u32 m0, s35, 18432
    s_add_u32 s32, s34, 376832
    buffer_load_dwordx4 v6, s[16:19], s32 offen lds
    s_add_u32 m0, s35, 19456
    s_add_u32 s32, s34, 385024
    buffer_load_dwordx4 v6, s[16:19], s32 offen lds
    ds_read_b64_tr_b16 v[100:101], v89 offset:22528
    ds_read_b64_tr_b16 v[102:103], v89 offset:23552
    ds_read_b64_tr_b16 v[104:105], v90 offset:22528
    ds_read_b64_tr_b16 v[106:107], v90 offset:23552
    s_waitcnt vmcnt(31) lgkmcnt(6)
    v_mfma_f32_32x32x16_bf16 v[108:123], v[92:95], v[24:27], v[108:123]
    s_waitcnt lgkmcnt(4)
    v_mfma_f32_32x32x16_bf16 v[124:139], v[96:99], v[24:27], v[124:139]
    s_waitcnt vmcnt(30)
    v_mfma_f32_32x32x16_bf16 v[140:155], v[92:95], v[28:31], v[140:155]
    v_mfma_f32_32x32x16_bf16 v[156:171], v[96:99], v[28:31], v[156:171]
    s_add_u32 s32, s33, 18432
    buffer_load_dwordx4 v[24:27], v5, s[12:15], s32 offen
    s_add_u32 s32, s33, 133120
    buffer_load_dwordx4 v[28:31], v5, s[12:15], s32 offen
    s_add_u32 m0, s35, 20480
    s_add_u32 s32, s34, 393216
    buffer_load_dwordx4 v6, s[16:19], s32 offen lds
    s_add_u32 m0, s35, 21504
    s_add_u32 s32, s34, 401408
    buffer_load_dwordx4 v6, s[16:19], s32 offen lds
    ds_read_b64_tr_b16 v[92:93], v89 offset:24576
    ds_read_b64_tr_b16 v[94:95], v89 offset:25600
    ds_read_b64_tr_b16 v[96:97], v90 offset:24576
    ds_read_b64_tr_b16 v[98:99], v90 offset:25600
    s_waitcnt vmcnt(31) lgkmcnt(6)
    v_mfma_f32_32x32x16_bf16 v[108:123], v[100:103], v[32:35], v[108:123]
    s_waitcnt lgkmcnt(4)
    v_mfma_f32_32x32x16_bf16 v[124:139], v[104:107], v[32:35], v[124:139]
    s_waitcnt vmcnt(30)
    v_mfma_f32_32x32x16_bf16 v[140:155], v[100:103], v[36:39], v[140:155]
    v_mfma_f32_32x32x16_bf16 v[156:171], v[104:107], v[36:39], v[156:171]
    s_add_u32 s32, s33, 19456
    buffer_load_dwordx4 v[32:35], v5, s[12:15], s32 offen
    s_add_u32 s32, s33, 134144
    buffer_load_dwordx4 v[36:39], v5, s[12:15], s32 offen
    s_add_u32 m0, s35, 22528
    s_add_u32 s32, s34, 409600
    buffer_load_dwordx4 v6, s[16:19], s32 offen lds
    s_add_u32 m0, s35, 23552
    s_add_u32 s32, s34, 417792
    buffer_load_dwordx4 v6, s[16:19], s32 offen lds
    ds_read_b64_tr_b16 v[100:101], v89 offset:26624
    ds_read_b64_tr_b16 v[102:103], v89 offset:27648
    ds_read_b64_tr_b16 v[104:105], v90 offset:26624
    ds_read_b64_tr_b16 v[106:107], v90 offset:27648
    s_waitcnt vmcnt(31) lgkmcnt(6)
    v_mfma_f32_32x32x16_bf16 v[108:123], v[92:95], v[40:43], v[108:123]
    s_waitcnt lgkmcnt(4)
    v_mfma_f32_32x32x16_bf16 v[124:139], v[96:99], v[40:43], v[124:139]
    s_waitcnt vmcnt(30)
    v_mfma_f32_32x32x16_bf16 v[140:155], v[92:95], v[44:47], v[140:155]
    v_mfma_f32_32x32x16_bf16 v[156:171], v[96:99], v[44:47], v[156:171]
    s_add_u32 s32, s33, 20480
    buffer_load_dwordx4 v[40:43], v5, s[12:15], s32 offen
    s_add_u32 s32, s33, 135168
    buffer_load_dwordx4 v[44:47], v5, s[12:15], s32 offen
    s_add_u32 m0, s35, 24576
    s_add_u32 s32, s34, 425984
    buffer_load_dwordx4 v6, s[16:19], s32 offen lds
    s_add_u32 m0, s35, 25600
    s_add_u32 s32, s34, 434176
    buffer_load_dwordx4 v6, s[16:19], s32 offen lds
    ds_read_b64_tr_b16 v[92:93], v89 offset:0
    ds_read_b64_tr_b16 v[94:95], v89 offset:1024
    ds_read_b64_tr_b16 v[96:97], v90 offset:0
    ds_read_b64_tr_b16 v[98:99], v90 offset:1024
    s_waitcnt vmcnt(31) lgkmcnt(6)
    v_mfma_f32_32x32x16_bf16 v[108:123], v[100:103], v[48:51], v[108:123]
    s_waitcnt lgkmcnt(4)
    v_mfma_f32_32x32x16_bf16 v[124:139], v[104:107], v[48:51], v[124:139]
    s_waitcnt vmcnt(30)
    v_mfma_f32_32x32x16_bf16 v[140:155], v[100:103], v[52:55], v[140:155]
    v_mfma_f32_32x32x16_bf16 v[156:171], v[104:107], v[52:55], v[156:171]
    s_add_u32 s32, s33, 21504
    buffer_load_dwordx4 v[48:51], v5, s[12:15], s32 offen
    s_add_u32 s32, s33, 136192
    buffer_load_dwordx4 v[52:55], v5, s[12:15], s32 offen
    s_add_u32 m0, s35, 26624
    s_add_u32 s32, s34, 442368
    buffer_load_dwordx4 v6, s[16:19], s32 offen lds
    s_add_u32 m0, s35, 27648
    s_add_u32 s32, s34, 450560
    buffer_load_dwordx4 v6, s[16:19], s32 offen lds
    ds_read_b64_tr_b16 v[100:101], v89 offset:2048
    ds_read_b64_tr_b16 v[102:103], v89 offset:3072
    ds_read_b64_tr_b16 v[104:105], v90 offset:2048
    ds_read_b64_tr_b16 v[106:107], v90 offset:3072
    s_waitcnt vmcnt(31) lgkmcnt(6)
    v_mfma_f32_32x32x16_bf16 v[108:123], v[92:95], v[56:59], v[108:123]
    s_waitcnt lgkmcnt(4)
    v_mfma_f32_32x32x16_bf16 v[124:139], v[96:99], v[56:59], v[124:139]
    s_waitcnt vmcnt(30)
    v_mfma_f32_32x32x16_bf16 v[140:155], v[92:95], v[60:63], v[140:155]
    v_mfma_f32_32x32x16_bf16 v[156:171], v[96:99], v[60:63], v[156:171]
    s_add_u32 s32, s33, 22528
    buffer_load_dwordx4 v[56:59], v5, s[12:15], s32 offen
    s_add_u32 s32, s33, 137216
    buffer_load_dwordx4 v[60:63], v5, s[12:15], s32 offen
    ds_read_b64_tr_b16 v[92:93], v89 offset:4096
    ds_read_b64_tr_b16 v[94:95], v89 offset:5120
    ds_read_b64_tr_b16 v[96:97], v90 offset:4096
    ds_read_b64_tr_b16 v[98:99], v90 offset:5120
    s_waitcnt vmcnt(29) lgkmcnt(6)
    v_mfma_f32_32x32x16_bf16 v[108:123], v[100:103], v[64:67], v[108:123]
    s_waitcnt lgkmcnt(4)
    v_mfma_f32_32x32x16_bf16 v[124:139], v[104:107], v[64:67], v[124:139]
    s_waitcnt vmcnt(28)
    v_mfma_f32_32x32x16_bf16 v[140:155], v[100:103], v[68:71], v[140:155]
    v_mfma_f32_32x32x16_bf16 v[156:171], v[104:107], v[68:71], v[156:171]
    s_add_u32 s32, s33, 23552
    buffer_load_dwordx4 v[64:67], v5, s[12:15], s32 offen
    s_add_u32 s32, s33, 138240
    buffer_load_dwordx4 v[68:71], v5, s[12:15], s32 offen
    ds_read_b64_tr_b16 v[100:101], v89 offset:6144
    ds_read_b64_tr_b16 v[102:103], v89 offset:7168
    ds_read_b64_tr_b16 v[104:105], v90 offset:6144
    ds_read_b64_tr_b16 v[106:107], v90 offset:7168
    s_waitcnt vmcnt(27) lgkmcnt(6)
    v_mfma_f32_32x32x16_bf16 v[108:123], v[92:95], v[8:11], v[108:123]
    s_waitcnt lgkmcnt(4)
    v_mfma_f32_32x32x16_bf16 v[124:139], v[96:99], v[8:11], v[124:139]
    s_waitcnt vmcnt(26)
    v_mfma_f32_32x32x16_bf16 v[140:155], v[92:95], v[12:15], v[140:155]
    v_mfma_f32_32x32x16_bf16 v[156:171], v[96:99], v[12:15], v[156:171]
    s_add_u32 s32, s33, 24576
    buffer_load_dwordx4 v[8:11], v5, s[12:15], s32 offen
    s_add_u32 s32, s33, 139264
    buffer_load_dwordx4 v[12:15], v5, s[12:15], s32 offen
    ds_read_b64_tr_b16 v[92:93], v89 offset:8192
    ds_read_b64_tr_b16 v[94:95], v89 offset:9216
    ds_read_b64_tr_b16 v[96:97], v90 offset:8192
    ds_read_b64_tr_b16 v[98:99], v90 offset:9216
    s_waitcnt vmcnt(25) lgkmcnt(6)
    v_mfma_f32_32x32x16_bf16 v[108:123], v[100:103], v[16:19], v[108:123]
    s_waitcnt lgkmcnt(4)
    v_mfma_f32_32x32x16_bf16 v[124:139], v[104:107], v[16:19], v[124:139]
    s_waitcnt vmcnt(24)
    v_mfma_f32_32x32x16_bf16 v[140:155], v[100:103], v[20:23], v[140:155]
    v_mfma_f32_32x32x16_bf16 v[156:171], v[104:107], v[20:23], v[156:171]
    s_add_u32 s32, s33, 25600
    buffer_load_dwordx4 v[16:19], v5, s[12:15], s32 offen
    s_add_u32 s32, s33, 140288
    buffer_load_dwordx4 v[20:23], v5, s[12:15], s32 offen
    ds_read_b64_tr_b16 v[100:101], v89 offset:10240
    ds_read_b64_tr_b16 v[102:103], v89 offset:11264
    ds_read_b64_tr_b16 v[104:105], v90 offset:10240
    ds_read_b64_tr_b16 v[106:107], v90 offset:11264
    s_waitcnt vmcnt(23) lgkmcnt(6)
    v_mfma_f32_32x32x16_bf16 v[108:123], v[92:95], v[24:27], v[108:123]
    s_waitcnt lgkmcnt(4)
    v_mfma_f32_32x32x16_bf16 v[124:139], v[96:99], v[24:27], v[124:139]
    s_waitcnt vmcnt(22)
    v_mfma_f32_32x32x16_bf16 v[140:155], v[92:95], v[28:31], v[140:155]
    v_mfma_f32_32x32x16_bf16 v[156:171], v[96:99], v[28:31], v[156:171]
    s_add_u32 s32, s33, 26624
    buffer_load_dwordx4 v[24:27], v5, s[12:15], s32 offen
    s_add_u32 s32, s33, 141312
    buffer_load_dwordx4 v[28:31], v5, s[12:15], s32 offen
    ds_read_b64_tr_b16 v[92:93], v89 offset:12288
    ds_read_b64_tr_b16 v[94:95], v89 offset:13312
    ds_read_b64_tr_b16 v[96:97], v90 offset:12288
    ds_read_b64_tr_b16 v[98:99], v90 offset:13312
    s_waitcnt vmcnt(21) lgkmcnt(6)
    v_mfma_f32_32x32x16_bf16 v[108:123], v[100:103], v[32:35], v[108:123]
    s_waitcnt lgkmcnt(4)
    v_mfma_f32_32x32x16_bf16 v[124:139], v[104:107], v[32:35], v[124:139]
    s_waitcnt vmcnt(20)
    v_mfma_f32_32x32x16_bf16 v[140:155], v[100:103], v[36:39], v[140:155]
    v_mfma_f32_32x32x16_bf16 v[156:171], v[104:107], v[36:39], v[156:171]
    s_add_u32 s32, s33, 27648
    buffer_load_dwordx4 v[32:35], v5, s[12:15], s32 offen
    s_add_u32 s32, s33, 142336
    buffer_load_dwordx4 v[36:39], v5, s[12:15], s32 offen
    ds_read_b64_tr_b16 v[100:101], v89 offset:14336
    ds_read_b64_tr_b16 v[102:103], v89 offset:15360
    ds_read_b64_tr_b16 v[104:105], v90 offset:14336
    ds_read_b64_tr_b16 v[106:107], v90 offset:15360
    s_waitcnt vmcnt(19) lgkmcnt(6)
    v_mfma_f32_32x32x16_bf16 v[108:123], v[92:95], v[40:43], v[108:123]
    s_waitcnt lgkmcnt(4)
    v_mfma_f32_32x32x16_bf16 v[124:139], v[96:99], v[40:43], v[124:139]
    s_waitcnt vmcnt(18)
    v_mfma_f32_32x32x16_bf16 v[140:155], v[92:95], v[44:47], v[140:155]
    v_mfma_f32_32x32x16_bf16 v[156:171], v[96:99], v[44:47], v[156:171]
    ds_read_b64_tr_b16 v[92:93], v89 offset:16384
    ds_read_b64_tr_b16 v[94:95], v89 offset:17408
    ds_read_b64_tr_b16 v[96:97], v90 offset:16384
    ds_read_b64_tr_b16 v[98:99], v90 offset:17408
    s_waitcnt vmcnt(15) lgkmcnt(6)
    v_mfma_f32_32x32x16_bf16 v[108:123], v[100:103], v[48:51], v[108:123]
    s_waitcnt lgkmcnt(4)
    v_mfma_f32_32x32x16_bf16 v[124:139], v[104:107], v[48:51], v[124:139]
    s_waitcnt vmcnt(14)
    v_mfma_f32_32x32x16_bf16 v[140:155], v[100:103], v[52:55], v[140:155]
    v_mfma_f32_32x32x16_bf16 v[156:171], v[104:107], v[52:55], v[156:171]
    ds_read_b64_tr_b16 v[100:101], v89 offset:18432
    ds_read_b64_tr_b16 v[102:103], v89 offset:19456
    ds_read_b64_tr_b16 v[104:105], v90 offset:18432
    ds_read_b64_tr_b16 v[106:107], v90 offset:19456
    s_waitcnt vmcnt(11) lgkmcnt(6)
    v_mfma_f32_32x32x16_bf16 v[108:123], v[92:95], v[56:59], v[108:123]
    s_waitcnt lgkmcnt(4)
    v_mfma_f32_32x32x16_bf16 v[124:139], v[96:99], v[56:59], v[124:139]
    s_waitcnt vmcnt(10)
    v_mfma_f32_32x32x16_bf16 v[140:155], v[92:95], v[60:63], v[140:155]
    v_mfma_f32_32x32x16_bf16 v[156:171], v[96:99], v[60:63], v[156:171]
    ds_read_b64_tr_b16 v[92:93], v89 offset:20480
    ds_read_b64_tr_b16 v[94:95], v89 offset:21504
    ds_read_b64_tr_b16 v[96:97], v90 offset:20480
    ds_read_b64_tr_b16 v[98:99], v90 offset:21504
    s_waitcnt vmcnt(9) lgkmcnt(6)
    v_mfma_f32_32x32x16_bf16 v[108:123], v[100:103], v[64:67], v[108:123]
    s_waitcnt lgkmcnt(4)
    v_mfma_f32_32x32x16_bf16 v[124:139], v[104:107], v[64:67], v[124:139]
    s_waitcnt vmcnt(8)
    v_mfma_f32_32x32x16_bf16 v[140:155], v[100:103], v[68:71], v[140:155]
    v_mfma_f32_32x32x16_bf16 v[156:171], v[104:107], v[68:71], v[156:171]
    ds_read_b64_tr_b16 v[100:101], v89 offset:22528
    ds_read_b64_tr_b16 v[102:103], v89 offset:23552
    ds_read_b64_tr_b16 v[104:105], v90 offset:22528
    ds_read_b64_tr_b16 v[106:107], v90 offset:23552
    s_waitcnt vmcnt(7) lgkmcnt(6)
    v_mfma_f32_32x32x16_bf16 v[108:123], v[92:95], v[8:11], v[108:123]
    s_waitcnt lgkmcnt(4)
    v_mfma_f32_32x32x16_bf16 v[124:139], v[96:99], v[8:11], v[124:139]
    s_waitcnt vmcnt(6)
    v_mfma_f32_32x32x16_bf16 v[140:155], v[92:95], v[12:15], v[140:155]
    v_mfma_f32_32x32x16_bf16 v[156:171], v[96:99], v[12:15], v[156:171]
    ds_read_b64_tr_b16 v[92:93], v89 offset:24576
    ds_read_b64_tr_b16 v[94:95], v89 offset:25600
    ds_read_b64_tr_b16 v[96:97], v90 offset:24576
    ds_read_b64_tr_b16 v[98:99], v90 offset:25600
    s_waitcnt vmcnt(5) lgkmcnt(6)
    v_mfma_f32_32x32x16_bf16 v[108:123], v[100:103], v[16:19], v[108:123]
    s_waitcnt lgkmcnt(4)
    v_mfma_f32_32x32x16_bf16 v[124:139], v[104:107], v[16:19], v[124:139]
    s_waitcnt vmcnt(4)
    v_mfma_f32_32x32x16_bf16 v[140:155], v[100:103], v[20:23], v[140:155]
    v_mfma_f32_32x32x16_bf16 v[156:171], v[104:107], v[20:23], v[156:171]
    ds_read_b64_tr_b16 v[100:101], v89 offset:26624
    ds_read_b64_tr_b16 v[102:103], v89 offset:27648
    ds_read_b64_tr_b16 v[104:105], v90 offset:26624
    ds_read_b64_tr_b16 v[106:107], v90 offset:27648
    s_waitcnt vmcnt(3) lgkmcnt(6)
    v_mfma_f32_32x32x16_bf16 v[108:123], v[92:95], v[24:27], v[108:123]
    s_waitcnt lgkmcnt(4)
    v_mfma_f32_32x32x16_bf16 v[124:139], v[96:99], v[24:27], v[124:139]
    s_waitcnt vmcnt(2)
    v_mfma_f32_32x32x16_bf16 v[140:155], v[92:95], v[28:31], v[140:155]
    v_mfma_f32_32x32x16_bf16 v[156:171], v[96:99], v[28:31], v[156:171]
    s_waitcnt vmcnt(1) lgkmcnt(2)
    v_mfma_f32_32x32x16_bf16 v[108:123], v[100:103], v[32:35], v[108:123]
    s_waitcnt lgkmcnt(0)
    v_mfma_f32_32x32x16_bf16 v[124:139], v[104:107], v[32:35], v[124:139]
    s_waitcnt vmcnt(0)
    v_mfma_f32_32x32x16_bf16 v[140:155], v[100:103], v[36:39], v[140:155]
    v_mfma_f32_32x32x16_bf16 v[156:171], v[104:107], v[36:39], v[156:171]
    v_add_u32 v172, s35, v5
    s_nop 5
    ds_write_b128 v172, v[108:111] offset:0
    ds_write_b128 v172, v[112:115] offset:1024
    ds_write_b128 v172, v[116:119] offset:2048
    ds_write_b128 v172, v[120:123] offset:3072
    ds_write_b128 v172, v[124:127] offset:4096
    ds_write_b128 v172, v[128:131] offset:5120
    ds_write_b128 v172, v[132:135] offset:6144
    ds_write_b128 v172, v[136:139] offset:7168
    ds_write_b128 v172, v[140:143] offset:8192
    ds_write_b128 v172, v[144:147] offset:9216
    ds_write_b128 v172, v[148:151] offset:10240
    ds_write_b128 v172, v[152:155] offset:11264
    ds_write_b128 v172, v[156:159] offset:12288
    ds_write_b128 v172, v[160:163] offset:13312
    ds_write_b128 v172, v[164:167] offset:14336
    ds_write_b128 v172, v[168:171] offset:15360
    s_waitcnt lgkmcnt(0)
    s_barrier
    s_lshl_b32 s31, s30, 12
    v_add_u32 v172, s31, v5
    v_add_u32 v173, 57344, v172
    ds_read_b128 v[108:111], v172 offset:0
    ds_read_b128 v[112:115], v172 offset:1024
    ds_read_b128 v[116:119], v172 offset:2048
    ds_read_b128 v[120:123], v172 offset:3072
    ds_read_b128 v[8:11], v172 offset:28672
    ds_read_b128 v[12:15], v172 offset:29696
    ds_read_b128 v[16:19], v172 offset:30720
    ds_read_b128 v[20:23], v172 offset:31744
    s_waitcnt lgkmcnt(3)
    v_add_f32 v108, v108, v8
    v_add_f32 v109, v109, v9
    v_add_f32 v110, v110, v10
    v_add_f32 v111, v111, v11
    s_waitcnt lgkmcnt(2)
    v_add_f32 v112, v112, v12
    v_add_f32 v113, v113, v13
    v_add_f32 v114, v114, v14
    v_add_f32 v115, v115, v15
    s_waitcnt lgkmcnt(1)
    v_add_f32 v116, v116, v16
    v_add_f32 v117, v117, v17
    v_add_f32 v118, v118, v18
    v_add_f32 v119, v119, v19
    s_waitcnt lgkmcnt(0)
    v_add_f32 v120, v120, v20
    v_add_f32 v121, v121, v21
    v_add_f32 v122, v122, v22
    v_add_f32 v123, v123, v23
    ds_read_b128 v[8:11], v173 offset:0
    ds_read_b128 v[12:15], v173 offset:1024
    ds_read_b128 v[16:19], v173 offset:2048
    ds_read_b128 v[20:23], v173 offset:3072
    s_waitcnt lgkmcnt(3)
    v_add_f32 v108, v108, v8
    v_add_f32 v109, v109, v9
    v_add_f32 v110, v110, v10
    v_add_f32 v111, v111, v11
    s_waitcnt lgkmcnt(2)
    v_add_f32 v112, v112, v12
    v_add_f32 v113, v113, v13
    v_add_f32 v114, v114, v14
    v_add_f32 v115, v115, v15
    s_waitcnt lgkmcnt(1)
    v_add_f32 v116, v116, v16
    v_add_f32 v117, v117, v17
    v_add_f32 v118, v118, v18
    v_add_f32 v119, v119, v19
    s_waitcnt lgkmcnt(0)
    v_add_f32 v120, v120, v20
    v_add_f32 v121, v121, v21
    v_add_f32 v122, v122, v22
    v_add_f32 v123, v123, v23
    ds_read_b128 v[8:11], v173 offset:28672
    ds_read_b128 v[12:15], v173 offset:29696
    ds_read_b128 v[16:19], v173 offset:30720
    ds_read_b128 v[20:23], v173 offset:31744
    s_waitcnt lgkmcnt(3)
    v_add_f32 v108, v108, v8
    v_add_f32 v109, v109, v9
    v_add_f32 v110, v110, v10
    v_add_f32 v111, v111, v11
    s_waitcnt lgkmcnt(2)
    v_add_f32 v112, v112, v12
    v_add_f32 v113, v113, v13
    v_add_f32 v114, v114, v14
    v_add_f32 v115, v115, v15
    s_waitcnt lgkmcnt(1)
    v_add_f32 v116, v116, v16
    v_add_f32 v117, v117, v17
    v_add_f32 v118, v118, v18
    v_add_f32 v119, v119, v19
    s_waitcnt lgkmcnt(0)
    v_add_f32 v120, v120, v20
    v_add_f32 v121, v121, v21
    v_add_f32 v122, v122, v22
    v_add_f32 v123, v123, v23
    v_cvt_pk_bf16_f32 v80, v108, v109
    v_cvt_pk_bf16_f32 v81, v110, v111
    v_cvt_pk_bf16_f32 v82, v112, v113
    v_cvt_pk_bf16_f32 v83, v114, v115
    v_cvt_pk_bf16_f32 v84, v116, v117
    v_cvt_pk_bf16_f32 v85, v118, v119
    v_cvt_pk_bf16_f32 v86, v120, v121
    v_cvt_pk_bf16_f32 v87, v122, v123
    v_lshlrev_b32 v2, 16, v80
    v_lshlrev_b32 v3, 16, v72
    v_add_f32 v108, v2, v3
    v_and_b32 v2, 0xffff0000, v80
    v_and_b32 v3, 0xffff0000, v72
    v_add_f32 v109, v2, v3
    v_lshlrev_b32 v2, 16, v81
    v_lshlrev_b32 v3, 16, v73
    v_add_f32 v110, v2, v3
    v_and_b32 v2, 0xffff0000, v81
    v_and_b32 v3, 0xffff0000, v73
    v_add_f32 v111, v2, v3
    v_lshlrev_b32 v2, 16, v82
    v_lshlrev_b32 v3, 16, v74
    v_add_f32 v112, v2, v3
    v_and_b32 v2, 0xffff0000, v82
    v_and_b32 v3, 0xffff0000, v74
    v_add_f32 v113, v2, v3
    v_lshlrev_b32 v2, 16, v83
    v_lshlrev_b32 v3, 16, v75
    v_add_f32 v114, v2, v3
    v_and_b32 v2, 0xffff0000, v83
    v_and_b32 v3, 0xffff0000, v75
    v_add_f32 v115, v2, v3
    v_lshlrev_b32 v2, 16, v84
    v_lshlrev_b32 v3, 16, v76
    v_add_f32 v116, v2, v3
    v_and_b32 v2, 0xffff0000, v84
    v_and_b32 v3, 0xffff0000, v76
    v_add_f32 v117, v2, v3
    v_lshlrev_b32 v2, 16, v85
    v_lshlrev_b32 v3, 16, v77
    v_add_f32 v118, v2, v3
    v_and_b32 v2, 0xffff0000, v85
    v_and_b32 v3, 0xffff0000, v77
    v_add_f32 v119, v2, v3
    v_lshlrev_b32 v2, 16, v86
    v_lshlrev_b32 v3, 16, v78
    v_add_f32 v120, v2, v3
    v_and_b32 v2, 0xffff0000, v86
    v_and_b32 v3, 0xffff0000, v78
    v_add_f32 v121, v2, v3
    v_lshlrev_b32 v2, 16, v87
    v_lshlrev_b32 v3, 16, v79
    v_add_f32 v122, v2, v3
    v_and_b32 v2, 0xffff0000, v87
    v_and_b32 v3, 0xffff0000, v79
    v_add_f32 v123, v2, v3
    v_cvt_pk_bf16_f32 v80, v108, v109
    v_cvt_pk_bf16_f32 v81, v110, v111
    v_cvt_pk_bf16_f32 v82, v112, v113
    v_cvt_pk_bf16_f32 v83, v114, v115
    v_cvt_pk_bf16_f32 v84, v116, v117
    v_cvt_pk_bf16_f32 v85, v118, v119
    v_cvt_pk_bf16_f32 v86, v120, v121
    v_cvt_pk_bf16_f32 v87, v122, v123
    s_mov_b32 s24, s10
    s_mov_b32 s25, s11
    s_and_b32 s25, s25, 0xffff
    s_mov_b32 s26, 2097152
    s_mov_b32 s27, 0x00020000
    buffer_store_dwordx2 v[80:81], v88, s[24:27], s38 offen offset:0
    buffer_store_dwordx2 v[82:83], v88, s[24:27], s38 offen offset:16
    buffer_store_dwordx2 v[84:85], v88, s[24:27], s38 offen offset:32
    buffer_store_dwordx2 v[86:87], v88, s[24:27], s38 offen offset:48
    s_waitcnt vmcnt(0)
L_k5_end:
    s_endpgm
k5_down_kernel_codeend:
.section .rodata,"a"
.p2align 6
.amdhsa_kernel k5_down_kernel
  .amdhsa_next_free_vgpr 176
  .amdhsa_next_free_sgpr 56
  .amdhsa_accum_offset 176
  .amdhsa_group_segment_fixed_size 0
  .amdhsa_kernarg_size 80
  .amdhsa_user_sgpr_count 2
  .amdhsa_user_sgpr_kernarg_segment_ptr 1
  .amdhsa_system_sgpr_workgroup_id_x 1
.end_amdhsa_kernel
.text
```
